```python
import torch

def _softmax(x, axis=-1):
    return torch.softmax(x, dim=axis)
def _gelu(x):
    return torch.nn.functional.gelu(x, approximate="tanh")
def _silu(x):
    return torch.nn.functional.silu(x)
def _sigmoid(x):
    return torch.sigmoid(x)
def _layernorm(x, axis=-1, eps=1e-5):
    m = x.mean(dim=axis, keepdim=True)
    v = x.var(dim=axis, keepdim=True, unbiased=False)
    return (x - m) / torch.sqrt(v + eps)
def _scatter_add(tgt, idx, src, axis=0):
    return tgt.clone().index_add_(axis, idx, src)
def _segment_sum(src, seg, n):
    out = torch.zeros((n,) + src.shape[1:], dtype=src.dtype)
    return out.index_add_(0, seg, src)
def _pad(x, pw):
    flat = tuple(v for pair in reversed(pw) for v in pair)
    return torch.nn.functional.pad(x, flat)

kernel_name = 'parallel_sum__ssm_conv_s5__dense_activation_mish__prompt'

def setup_inputs():

    _w = (lambda a: (lambda t: t.to(torch.bfloat16) if t.is_floating_point() else t)(torch.as_tensor(a)))
    def _A_setup():
        B, S, D = 1, 2048, 512
        P = D
        Lambda_re = -0.5 * (lambda _x: torch.exp(torch.as_tensor(_x)))((lambda *s: torch.randn(*s, dtype=torch.bfloat16) * 0.2)(P))
        Lambda_im = (lambda *s: torch.randn(*s, dtype=torch.bfloat16) * 0.8)(P) * 1.0
        B_re = (lambda *s: torch.randn(*s, dtype=torch.bfloat16) * 0.2)(P, D) * (D ** -0.5)
        B_im = (lambda *s: torch.randn(*s, dtype=torch.bfloat16) * 0.2)(P, D) * (D ** -0.5)
        C_re = (lambda *s: torch.randn(*s, dtype=torch.bfloat16) * 0.2)(D, P) * (P ** -0.5)
        C_im = (lambda *s: torch.randn(*s, dtype=torch.bfloat16) * 0.2)(D, P) * (P ** -0.5)
        log_dt = (lambda *s: torch.randn(*s, dtype=torch.bfloat16) * 0.2)(P) * 0.3 - 2.0
        Dskip = (lambda *s: torch.randn(*s, dtype=torch.bfloat16) * 0.05)(D)
        return {
            "x": _w((lambda *s: torch.randn(*s, dtype=torch.bfloat16) * 0.05)(B, S, D)),
            "Lambda_re": _w(Lambda_re),
            "Lambda_im": _w(Lambda_im),
            "B_re": _w(B_re),
            "B_im": _w(B_im),
            "C_re": _w(C_re),
            "C_im": _w(C_im),
            "log_dt": _w(log_dt),
            "Dskip": _w(Dskip),
        }
    _A_in = _A_setup()

    def _B_setup():
        B, S, D, F = 1, 2048, 512, 1792
        return {
            "x": _w((lambda *s: torch.randn(*s, dtype=torch.bfloat16) * 0.05)(B, S, D)),
            "w1": _w((lambda *s: torch.randn(*s, dtype=torch.bfloat16) * 0.8)(D, F) * (D ** -0.5)),
            "b1": _w((lambda *s: torch.randn(*s, dtype=torch.bfloat16) * 0.2)(F)),
            "w2": _w((lambda *s: torch.randn(*s, dtype=torch.bfloat16) * 0.2)(F, D) * (F ** -0.5)),
        }
    _B_in = _B_setup()

    return {
        "A_x": _A_in["x"],
        "A_Lambda_re": _A_in["Lambda_re"],
        "A_Lambda_im": _A_in["Lambda_im"],
        "A_B_re": _A_in["B_re"],
        "A_B_im": _A_in["B_im"],
        "A_C_re": _A_in["C_re"],
        "A_C_im": _A_in["C_im"],
        "A_log_dt": _A_in["log_dt"],
        "A_Dskip": _A_in["Dskip"],
        "B_x": _B_in["x"],
        "B_w1": _B_in["w1"],
        "B_b1": _B_in["b1"],
        "B_w2": _B_in["w2"],
    }

def reference(A_x, A_Lambda_re, A_Lambda_im, A_B_re, A_B_im, A_C_re, A_C_im, A_log_dt, A_Dskip, B_x, B_w1, B_b1, B_w2):
    def _A_ref(x, Lambda_re, Lambda_im, B_re, B_im, C_re, C_im, log_dt, Dskip):
        Bsz, L, H = x.shape
        Lam = Lambda_re + 1j * Lambda_im
        Bmat = B_re + 1j * B_im
        Cmat = C_re + 1j * C_im
        dt = torch.exp(log_dt)
        Lam_bar = torch.exp(dt * Lam)
        B_bar = ((Lam_bar - 1.0) / Lam)[:, None] * Bmat
        Bu = torch.einsum("bld,pd->blp", x + 0j, B_bar)
        h = torch.zeros_like(Bu[:, 0, :])
        hs = []
        for t in range(L):
            h = Lam_bar[None, :] * h + Bu[:, t, :]
            hs.append(h)
        hseq = torch.stack(hs, 1)
        y = 2.0 * torch.einsum("blp,dp->bld", hseq, Cmat).real + x * Dskip[None, None, :]
        return y

    def _B_ref(x, w1, b1, w2):
        h = torch.einsum("bsd,df->bsf", x, w1) + b1
        sp = torch.log1p(torch.exp(-torch.abs(h))) + torch.where(h > 0, h, torch.zeros_like(h))
        act = h * torch.tanh(sp)
        return torch.einsum("bsf,fd->bsd", act, w2)

    x = A_x
    xn = _layernorm(x, axis=-1)
    return x + _A_ref(xn, A_Lambda_re, A_Lambda_im, A_B_re, A_B_im, A_C_re, A_C_im, A_log_dt, A_Dskip) + _B_ref(xn, B_w1, B_b1, B_w2)
```

```asm
; @launch grid=(256,1,1) block=(256,1,1) lds=163840
.amdgcn_target "amdgcn-amd-amdhsa--gfx950"
.text
.globl parallel_sum__ssm_conv_s5__dense_activation_mish__prompt_kernel
.p2align 8
.type parallel_sum__ssm_conv_s5__dense_activation_mish__prompt_kernel,@function
parallel_sum__ssm_conv_s5__dense_activation_mish__prompt_kernel:
    s_cmp_ge_u32 s2, 256
    s_cbranch_scc1 L_end
    s_load_dwordx16 s[16:31], s[0:1], 0
    s_load_dwordx16 s[32:47], s[0:1], 64
    v_and_b32 v1, 63, v0
    v_lshrrev_b32 v228, 6, v0
    v_and_b32 v2, 31, v0
    v_readfirstlane_b32 s6, v228
    v_lshrrev_b32 v3, 5, v1
    v_lshlrev_b32 v4, 4, v1
    s_and_b32 s14, s2, 7
    s_lshr_b32 s15, s2, 3
    s_mov_b32 s101, s14
    s_mov_b32 s95, s15
    s_getpc_b64 s[96:97]
L_pc:
    s_sub_u32 s96, s96, L_pc-parallel_sum__ssm_conv_s5__dense_activation_mish__prompt_kernel
    s_subb_u32 s97, s97, 0
    s_lshl_b32 s3, s6, 5
    s_add_u32 s3, s3, s15
    s_lshl_b32 s3, s3, 8
    v_lshl_add_u32 v247, v1, 2, s3
    v_min_u32 v247, L_end-parallel_sum__ssm_conv_s5__dense_activation_mish__prompt_kernel, v247
    global_load_dword a255, v247, s[96:97]
    s_lshr_b32 s3, s14, 1
    s_lshl_b32 s3, s3, 2
    s_and_b32 s4, s15, 3
    s_or_b32 s4, s4, s3
    s_and_b32 s3, s14, 1
    s_lshl_b32 s3, s3, 3
    s_lshr_b32 s5, s15, 2
    s_or_b32 s5, s5, s3
    s_mov_b32 s7, 0
    s_cmp_gt_u32 s5, 3
    s_subb_u32 s97, s5, 0
    s_cmp_gt_u32 s5, 11
    s_subb_u32 s97, s97, 0
    s_lshl_b32 s93, s6, 12
    s_lshl_b32 s94, s6, 13
    v_lshrrev_b32 v228, 3, v1
    v_and_b32 v229, 7, v1
    v_lshrrev_b32 v230, 4, v1
    v_xor_b32 v229, v229, v230
    v_lshlrev_b32 v229, 4, v229
    v_and_b32 v230, 3, v228
    v_lshl_add_u32 v230, v3, 4, v230
    v_lshl_add_u32 v6, v230, 10, v229
    v_xor_b32 v7, 64, v6
    v_add_u32 v8, 6144, v6
    v_add_u32 v9, 9216, v7
    v_add_u32 v7, 3072, v7
    v_lshl_add_u32 v10, v228, 10, v229
    v_xor_b32 v11, 64, v10
    v_add_u32 v12, 14336, v10
    v_add_u32 v13, 21504, v11
    v_add_u32 v11, 7168, v11
    v_lshlrev_b32 v228, 10, v3
    v_lshl_add_u32 v228, v2, 4, v228
    s_lshl_b32 s84, s4, 17
    s_lshl_b32 s3, s6, 15
    s_add_u32 s84, s84, s3
    s_and_b32 s3, s6, 1
    s_lshl_b32 s3, s3, 14
    s_lshl_b32 s85, s5, 15
    s_add_u32 s85, s85, s3
    v_lshrrev_b32 v230, 4, v1
    v_and_b32 v231, 15, v1
    v_lshlrev_b32 v229, 2, v230
    v_xor_b32 v231, v231, v229
    v_lshlrev_b32 v231, 4, v231
    v_mul_u32_u24 v230, 3584, v230
    v_add_u32 v14, v230, v231
    v_add_u32 v15, 13312, v14
    v_add_u32 v16, 26624, v14
    v_add_u32 v17, 39936, v14
    s_mul_i32 s86, s6, 57344
    s_lshl_b32 s3, s97, 8
    s_add_u32 s86, s86, s3
    s_lshl_b32 s3, s4, 4
    s_add_u32 s3, s3, s5
    s_lshl_b32 s3, s3, 2
    s_add_u32 s3, s3, s6
    s_lshl_b32 s14, s3, 11
    s_lshl_b32 s3, s5, 5
    v_add_lshl_u32 v229, v2, s3, 1
    s_lshl_b32 s3, s97, 7
    v_add_lshl_u32 v230, v1, s3, 1
    v_min_u32 v230, 3454, v230
    s_and_b32 s9, s5, 7
    s_lshl_b32 s3, s9, 1
    s_and_b32 s15, s6, 1
    s_or_b32 s3, s3, s15
    s_lshl_b32 s3, s3, 5
    v_add_lshl_u32 v231, v2, s3, 1
    s_waitcnt lgkmcnt(0)
    s_mov_b32 s48, s16
    s_mov_b32 s49, s17
    s_mov_b32 s50, 0x200000
    s_mov_b32 s51, 0x20000
    s_mov_b32 s11, s14
    s_load_dword s10, s[46:47], 0
    s_mov_b32 s52, s36
    s_mov_b32 s53, s37
    s_mov_b32 s54, 0x1c0000
    s_mov_b32 s55, 0x20000
    s_cmp_lt_u32 s6, 2
    s_cselect_b32 s56, s22, s24
    s_cselect_b32 s57, s23, s25
    s_mov_b32 s58, 0x80000
    s_mov_b32 s59, 0x20000
    s_cmp_eq_u32 s9, 3
    s_cbranch_scc1 L_light
    s_xor_b32 s3, s7, 0
    s_mul_i32 s89, s3, 229376
    s_lshl_b32 s3, s3, 7
    s_add_u32 s13, s3, s85
    s_add_u32 s12, s3, s84
    s_add_u32 s89, s89, s86
    s_add_u32 m0, s93, 0
    s_nop 0
    buffer_load_dwordx4 v6, s[48:51], s12 offen offset:0 lds
    buffer_load_dwordx4 v7, s[48:51], s12 offen offset:1024 lds
    buffer_load_dwordx4 v8, s[48:51], s12 offen offset:2048 lds
    buffer_load_dwordx4 v9, s[48:51], s12 offen offset:3072 lds
    s_lshr_b32 s3, s93, 1
    s_add_u32 m0, s3, 32768
    s_nop 0
    buffer_load_dwordx4 v10, s[56:59], s13 offen offset:0 lds
    buffer_load_dwordx4 v11, s[56:59], s13 offen offset:1024 lds
    s_add_u32 m0, s93, 16384
    s_nop 0
    buffer_load_dwordx4 v14, s[52:55], s89 offen offset:0 lds
    buffer_load_dwordx4 v15, s[52:55], s89 offen offset:1024 lds
    buffer_load_dwordx4 v16, s[52:55], s89 offen offset:2048 lds
    buffer_load_dwordx4 v17, s[52:55], s89 offen offset:3072 lds
    global_load_ushort v212, v229, s[18:19]
    global_load_ushort v213, v229, s[20:21]
    global_load_ushort v214, v229, s[30:31]
    global_load_ushort v251, v230, s[38:39]
    global_load_ushort v252, v230, s[38:39] offset:128
    global_load_ushort v250, v231, s[32:33]
    s_xor_b32 s3, s7, 1
    s_mul_i32 s89, s3, 229376
    s_lshl_b32 s3, s3, 7
    s_add_u32 s13, s3, s85
    s_add_u32 s12, s3, s84
    s_add_u32 s89, s89, s86
    s_add_u32 m0, s93, 40960
    s_nop 0
    buffer_load_dwordx4 v6, s[48:51], s12 offen offset:0 lds
    s_mov_b32 s76, s46
    s_mov_b32 s77, s47
    s_mov_b32 s78, 0x10000000
    s_mov_b32 s79, 0x20000
    s_mov_b32 s98, 0
    s_mov_b32 s99, -1
    v_bfe_u32 v240, v2, 1, 3
    v_xor_b32 v240, v240, v3
    v_lshlrev_b32 v240, 4, v240
    v_lshl_add_u32 v240, v2, 7, v240
    buffer_load_dwordx4 v7, s[48:51], s12 offen offset:1024 lds
    v_add_u32 v22, s93, v240
    v_add_u32 v30, 32768, v240
    v_add_u32 v34, s94, v240
    v_xor_b32 v23, 32, v22
    v_xor_b32 v31, 32, v30
    buffer_load_dwordx4 v8, s[48:51], s12 offen offset:2048 lds
    v_xor_b32 v24, 64, v22
    v_xor_b32 v32, 64, v30
    v_xor_b32 v25, 96, v22
    v_xor_b32 v33, 96, v30
    v_bfe_u32 v240, v1, 2, 2
    buffer_load_dwordx4 v9, s[48:51], s12 offen offset:3072 lds
    v_and_b32 v241, 3, v1
    v_lshlrev_b32 v241, 3, v241
    v_bfe_u32 v242, v1, 4, 1
    v_lshl_add_u32 v241, v242, 5, v241
    v_lshl_add_u32 v242, v3, 3, v240
    s_lshr_b32 s3, s93, 1
    s_add_u32 m0, s3, 73728
    s_nop 0
    buffer_load_dwordx4 v10, s[56:59], s13 offen offset:0 lds
    v_lshl_add_u32 v242, v242, 8, v241
    v_lshl_add_u32 v242, v240, 6, v242
    v_add_u32 v26, 16384, v242
    v_xor_b32 v27, 64, v26
    v_xor_b32 v28, 128, v26
    buffer_load_dwordx4 v11, s[56:59], s13 offen offset:1024 lds
    v_xor_b32 v29, 192, v26
    v_lshrrev_b32 v242, 1, v240
    v_lshl_add_u32 v241, v242, 6, v241
    v_lshl_add_u32 v242, v3, 2, v240
    v_lshl_add_u32 v242, v242, 7, v241
    s_add_u32 m0, s93, 57344
    s_nop 0
    buffer_load_dwordx4 v14, s[52:55], s89 offen offset:0 lds
    v_add_u32 v42, s94, v242
    s_mov_b32 s64, s40
    s_mov_b32 s65, s41
    s_mov_b32 s66, 0x1c0000
    s_mov_b32 s67, 0x20000
    s_mov_b32 s68, s26
    s_mov_b32 s69, s27
    s_mov_b32 s70, 0x80000
    s_mov_b32 s71, 0x20000
    s_mov_b32 s72, s28
    s_mov_b32 s73, s29
    s_mov_b32 s74, 0x80000
    s_mov_b32 s75, 0x20000
    buffer_load_dwordx4 v15, s[52:55], s89 offen offset:1024 lds
    s_mov_b32 s80, s42
    s_mov_b32 s81, s43
    s_mov_b32 s82, 0x400000
    s_mov_b32 s83, 0x20000
    s_lshl_b32 s3, s5, 13
    s_add_u32 s60, s46, s3
    s_addc_u32 s61, s47, 0
    s_add_u32 s60, s60, 262144
    s_addc_u32 s61, s61, 0
    s_mov_b32 s62, 8192
    s_mov_b32 s63, 0x20000
    s_lshr_b32 s3, s5, 3
    s_lshl_b32 s8, s4, 1
    s_or_b32 s8, s8, s3
    s_and_b32 s16, s9, 3
    s_cmp_eq_u32 s16, 3
    s_cselect_b32 s16, 0, s16
    buffer_load_dwordx4 v16, s[52:55], s89 offen offset:2048 lds
    s_cmp_eq_u32 s6, 3
    s_cselect_b32 s3, 1, 0
    s_lshl_b32 s24, s6, 2
    s_sub_u32 s24, s24, s3
    s_mul_i32 s25, s6, 3
    s_add_u32 s25, s25, s3
    s_lshl_b32 s21, s24, 13
    s_lshl_b32 s23, s25, 13
    s_add_u32 s23, s23, 4096
    s_add_u32 s22, s21, 24576
    s_add_u32 s3, s23, 8192
    s_cmp_lt_u32 s6, 2
    s_cselect_b32 s22, s22, s23
    s_cselect_b32 s23, s23, s3
    s_mul_i32 s21, s6, 28672
    s_mul_i32 s24, s6, 7
    s_lshr_b32 s24, s24, 1
    buffer_load_dwordx4 v17, s[52:55], s89 offen offset:3072 lds
    s_lshl_b32 s3, s9, 7
    s_lshl_b32 s18, s21, 4
    s_lshl_b32 s19, s22, 4
    s_lshl_b32 s20, s23, 4
    s_add_u32 s18, s18, s3
    s_add_u32 s19, s19, s3
    s_add_u32 s20, s20, s3
    s_lshl_b32 s3, s4, 2
    s_add_u32 s3, s3, s6
    s_mul_i32 s91, s3, 180224
    s_add_u32 s91, s91, 1048576
    s_waitcnt lgkmcnt(0)
    s_mul_i32 s10, s10, 0x9e3779b1
    s_add_u32 s10, s10, 0x7f4a7c15
    s_xor_b32 s3, s7, 2
    s_mul_i32 s89, s3, 229376
    s_lshl_b32 s3, s3, 7
    s_add_u32 s13, s3, s85
    s_add_u32 s12, s3, s84
    s_add_u32 s89, s89, s86
    s_add_u32 m0, s93, 81920
    s_nop 0
    buffer_load_dwordx4 v6, s[48:51], s12 offen offset:0 lds
    v_xor_b32 v35, 32, v34
    v_xor_b32 v36, 64, v34
    v_xor_b32 v37, 96, v34
    v_add_u32 v38, 81920, v34
    v_add_u32 v39, 81920, v35
    v_add_u32 v40, 81920, v36
    v_add_u32 v41, 81920, v37
    v_xor_b32 v43, 64, v42
    v_add_u32 v44, 81920, v42
    v_add_u32 v45, 81920, v43
    v_lshrrev_b32 v240, 3, v1
    v_and_b32 v241, 7, v1
    v_bfe_u32 v242, v1, 4, 1
    v_lshlrev_b32 v242, 2, v242
    v_xor_b32 v241, v241, v242
    v_lshlrev_b32 v241, 4, v241
    s_and_b32 s3, s6, 1
    s_lshl_b32 s3, s3, 6
    v_xor_b32 v241, s3, v241
    v_lshl_add_u32 v18, v240, 10, v241
    v_add_u32 v19, 7168, v18
    buffer_load_dwordx4 v7, s[48:51], s12 offen offset:1024 lds
    v_add_u32 v20, 14336, v18
    v_add_u32 v21, 21504, v18
    v_bfe_u32 v240, v2, 2, 1
    v_lshrrev_b32 v241, 3, v2
    v_and_b32 v242, 3, v2
    v_lshl_add_u32 v242, v241, 2, v242
    v_lshl_add_u32 v5, v240, 4, v242
    v_mov_b32 v194, 0
    v_mov_b32 v195, 0
    v_mov_b32 v198, 0
    v_mov_b32 v199, 0
    v_mov_b32 v202, 0
    v_mov_b32 v203, 0
    v_mov_b32 v206, 0
    v_mov_b32 v207, 0
    v_mov_b32 v210, 0
    v_mov_b32 v211, 0
    s_waitcnt vmcnt(12)
    v_lshlrev_b32 v212, 16, v212
    v_lshlrev_b32 v213, 16, v213
    buffer_load_dwordx4 v8, s[48:51], s12 offen offset:2048 lds
    v_lshlrev_b32 v214, 16, v214
    v_lshlrev_b32 v250, 16, v250
    v_mul_f32 v214, 0x3fb8aa3b, v214
    v_exp_f32 v214, v214
    s_nop 0
    v_cvt_pk_bf16_f32 v214, v214, v214
    v_and_b32 v214, 0xffff0000, v214
    v_mul_f32 v215, v214, v212
    v_mul_f32 v216, v214, v213
    v_mul_f32 v215, 0x3fb8aa3b, v215
    v_mul_f32 v216, 0.15915494, v216
    v_mul_f32 v217, 1.0, v215
    v_mul_f32 v218, 1.0, v216
    v_exp_f32 v217, v217
    v_fract_f32 v218, v218
    v_cos_f32 v46, v218
    v_sin_f32 v47, v218
    buffer_load_dwordx4 v9, s[48:51], s12 offen offset:3072 lds
    v_mul_f32 v46, v46, v217
    v_mul_f32 v47, v47, v217
    v_mul_f32 v217, 0x41800000, v215
    v_mul_f32 v218, 0x41800000, v216
    v_exp_f32 v217, v217
    v_fract_f32 v218, v218
    v_cos_f32 v49, v218
    v_sin_f32 v50, v218
    v_mul_f32 v49, v49, v217
    v_mul_f32 v50, v50, v217
    v_mul_f32 v217, 0x43800000, v215
    v_mul_f32 v218, 0x43800000, v216
    v_exp_f32 v217, v217
    v_fract_f32 v218, v218
    s_lshr_b32 s3, s93, 1
    s_add_u32 m0, s3, 114688
    s_nop 0
    buffer_load_dwordx4 v10, s[56:59], s13 offen offset:0 lds
    v_cos_f32 v54, v218
    v_sin_f32 v55, v218
    v_mul_f32 v54, v54, v217
    v_mul_f32 v55, v55, v217
    s_lshl_b32 s3, s6, 1
    v_add_u32 v219, s3, v3
    v_lshlrev_b32 v219, 4, v219
    v_cvt_f32_u32 v219, v219
    v_mul_f32 v217, v219, v215
    v_mul_f32 v218, v219, v216
    v_exp_f32 v217, v217
    v_fract_f32 v218, v218
    v_cos_f32 v52, v218
    v_sin_f32 v53, v218
    v_mul_f32 v52, v52, v217
    buffer_load_dwordx4 v11, s[56:59], s13 offen offset:1024 lds
    v_mul_f32 v53, v53, v217
    s_lshl_b32 s3, s6, 2
    v_add_u32 v219, s3, v3
    v_lshlrev_b32 v219, 7, v219
    v_cvt_f32_u32 v219, v219
    v_mul_f32 v217, v219, v215
    v_mul_f32 v218, v219, v216
    v_exp_f32 v217, v217
    v_fract_f32 v218, v218
    v_cos_f32 v56, v218
    v_sin_f32 v57, v218
    v_mul_f32 v56, v56, v217
    v_mul_f32 v57, v57, v217
    v_sub_f32 v48, 0, v47
    v_sub_f32 v51, 0, v50
    v_mul_f32 v217, v212, v212
    s_add_u32 m0, s93, 98304
    s_nop 0
    buffer_load_dwordx4 v14, s[52:55], s89 offen offset:0 lds
    v_fmac_f32 v217, v213, v213
    v_rcp_f32 v217, v217
    v_subrev_f32 v218, 1.0, v46
    v_mul_f32 v58, v218, v212
    v_mul_f32 v60, v218, v213
    v_mul_f32 v217, 0x4038aa3b, v217
    v_fmac_f32 v58, v47, v213
    v_fmac_f32 v60, v48, v212
    v_mul_f32 v58, v58, v217
    v_mul_f32 v60, v60, v217
    v_sub_f32 v59, 0, v58
    v_mul_f32 v160, v58, v46
    v_mul_f32 v176, v58, v47
    v_fmac_f32 v160, v60, v47
    v_fma_f32 v176, -v60, v46, v176
    v_mul_f32 v161, v160, v46
    v_mul_f32 v177, v176, v46
    v_fmac_f32 v161, v176, v48
    buffer_load_dwordx4 v15, s[52:55], s89 offen offset:1024 lds
    v_fmac_f32 v177, v160, v47
    v_mul_f32 v162, v161, v46
    v_mul_f32 v178, v177, v46
    v_fmac_f32 v162, v177, v48
    v_fmac_f32 v178, v161, v47
    v_mul_f32 v163, v162, v46
    v_mul_f32 v179, v178, v46
    v_fmac_f32 v163, v178, v48
    v_fmac_f32 v179, v162, v47
    v_mul_f32 v164, v163, v46
    v_mul_f32 v180, v179, v46
    v_fmac_f32 v164, v179, v48
    v_fmac_f32 v180, v163, v47
    v_mul_f32 v165, v164, v46
    v_mul_f32 v181, v180, v46
    v_fmac_f32 v165, v180, v48
    v_fmac_f32 v181, v164, v47
    v_mul_f32 v166, v165, v46
    v_mul_f32 v182, v181, v46
    buffer_load_dwordx4 v16, s[52:55], s89 offen offset:2048 lds
    v_fmac_f32 v166, v181, v48
    v_fmac_f32 v182, v165, v47
    v_mul_f32 v167, v166, v46
    v_mul_f32 v183, v182, v46
    v_fmac_f32 v167, v182, v48
    v_fmac_f32 v183, v166, v47
    v_mul_f32 v168, v167, v46
    v_mul_f32 v184, v183, v46
    v_fmac_f32 v168, v183, v48
    v_fmac_f32 v184, v167, v47
    v_mul_f32 v169, v168, v46
    v_mul_f32 v185, v184, v46
    v_fmac_f32 v169, v184, v48
    v_fmac_f32 v185, v168, v47
    v_mul_f32 v170, v169, v46
    v_mul_f32 v186, v185, v46
    v_fmac_f32 v170, v185, v48
    v_fmac_f32 v186, v169, v47
    v_mul_f32 v171, v170, v46
    buffer_load_dwordx4 v17, s[52:55], s89 offen offset:3072 lds
    v_mul_f32 v187, v186, v46
    v_fmac_f32 v171, v186, v48
    v_fmac_f32 v187, v170, v47
    v_mul_f32 v172, v171, v46
    v_mul_f32 v188, v187, v46
    v_fmac_f32 v172, v187, v48
    v_fmac_f32 v188, v171, v47
    v_mul_f32 v173, v172, v46
    v_mul_f32 v189, v188, v46
    v_fmac_f32 v173, v188, v48
    v_fmac_f32 v189, v172, v47
    v_mul_f32 v174, v173, v46
    v_mul_f32 v190, v189, v46
    v_fmac_f32 v174, v189, v48
    v_fmac_f32 v190, v173, v47
    v_mul_f32 v175, v174, v46
    v_mul_f32 v191, v190, v46
    v_fmac_f32 v175, v190, v48
    v_fmac_f32 v191, v174, v47
    s_barrier
    ds_read_b128 a[128:131], v22 offset:0
    ds_read_b128 a[132:135], v30 offset:0
    ds_read_b128 a[136:139], v30 offset:4096
    ds_read_b64_tr_b16 a[140:141], v26 offset:0
    ds_read_b64_tr_b16 a[142:143], v26 offset:1024
    ds_read_b64_tr_b16 a[144:145], v27 offset:0
    ds_read_b64_tr_b16 a[146:147], v27 offset:1024
    ds_read_b64_tr_b16 a[148:149], v28 offset:0
    ds_read_b64_tr_b16 a[150:151], v28 offset:1024
    ds_read_b64_tr_b16 a[152:153], v29 offset:0
    ds_read_b64_tr_b16 a[154:155], v29 offset:1024
    s_waitcnt lgkmcnt(6)
    v_mfma_f32_32x32x16_bf16 v[128:143], a[128:131], a[132:135], 0
    ds_read_b128 a[156:159], v23 offset:0
    ds_read_b128 a[160:163], v31 offset:0
    v_mfma_f32_32x32x16_bf16 v[144:159], a[128:131], a[136:139], 0
    ds_read_b128 a[164:167], v31 offset:4096
    ds_read_b64_tr_b16 a[168:169], v26 offset:4096
    v_mfma_f32_32x32x16_bf16 v[64:79], a[140:143], a[128:131], 0
    ds_read_b64_tr_b16 a[170:171], v26 offset:5120
    ds_read_b64_tr_b16 a[172:173], v27 offset:4096
    s_waitcnt lgkmcnt(6)
    v_mfma_f32_32x32x16_bf16 v[80:95], a[144:147], a[128:131], 0
    ds_read_b64_tr_b16 a[174:175], v27 offset:5120
    ds_read_b64_tr_b16 a[176:177], v28 offset:4096
    v_mfma_f32_32x32x16_bf16 v[96:111], a[148:151], a[128:131], 0
    ds_read_b64_tr_b16 a[178:179], v28 offset:5120
    ds_read_b64_tr_b16 a[180:181], v29 offset:4096
    v_mfma_f32_32x32x16_bf16 v[112:127], a[152:155], a[128:131], 0
    ds_read_b64_tr_b16 a[182:183], v29 offset:5120
    s_waitcnt lgkmcnt(6)
    v_mfma_f32_32x32x16_bf16 v[128:143], a[156:159], a[160:163], v[128:143]
    ds_read_b128 a[128:131], v24 offset:0
    ds_read_b128 a[132:135], v32 offset:0
    v_mfma_f32_32x32x16_bf16 v[144:159], a[156:159], a[164:167], v[144:159]
    ds_read_b128 a[136:139], v32 offset:4096
    ds_read_b64_tr_b16 a[140:141], v26 offset:8192
    v_mfma_f32_32x32x16_bf16 v[64:79], a[168:171], a[156:159], v[64:79]
    ds_read_b64_tr_b16 a[142:143], v26 offset:9216
    ds_read_b64_tr_b16 a[144:145], v27 offset:8192
    s_waitcnt lgkmcnt(6)
    v_mfma_f32_32x32x16_bf16 v[80:95], a[172:175], a[156:159], v[80:95]
    ds_read_b64_tr_b16 a[146:147], v27 offset:9216
    ds_read_b64_tr_b16 a[148:149], v28 offset:8192
    v_mfma_f32_32x32x16_bf16 v[96:111], a[176:179], a[156:159], v[96:111]
    ds_read_b64_tr_b16 a[150:151], v28 offset:9216
    ds_read_b64_tr_b16 a[152:153], v29 offset:8192
    v_mfma_f32_32x32x16_bf16 v[112:127], a[180:183], a[156:159], v[112:127]
    ds_read_b64_tr_b16 a[154:155], v29 offset:9216
    s_waitcnt lgkmcnt(6)
    v_mfma_f32_32x32x16_bf16 v[128:143], a[128:131], a[132:135], v[128:143]
    ds_read_b128 a[156:159], v25 offset:0
    ds_read_b128 a[160:163], v33 offset:0
    v_mfma_f32_32x32x16_bf16 v[144:159], a[128:131], a[136:139], v[144:159]
    ds_read_b128 a[164:167], v33 offset:4096
    ds_read_b64_tr_b16 a[168:169], v26 offset:12288
    v_mfma_f32_32x32x16_bf16 v[64:79], a[140:143], a[128:131], v[64:79]
    ds_read_b64_tr_b16 a[170:171], v26 offset:13312
    ds_read_b64_tr_b16 a[172:173], v27 offset:12288
    s_waitcnt lgkmcnt(6)
    v_mfma_f32_32x32x16_bf16 v[80:95], a[144:147], a[128:131], v[80:95]
    ds_read_b64_tr_b16 a[174:175], v27 offset:13312
    ds_read_b64_tr_b16 a[176:177], v28 offset:12288
    v_mfma_f32_32x32x16_bf16 v[96:111], a[148:151], a[128:131], v[96:111]
    ds_read_b64_tr_b16 a[178:179], v28 offset:13312
    ds_read_b64_tr_b16 a[180:181], v29 offset:12288
    v_mfma_f32_32x32x16_bf16 v[112:127], a[152:155], a[128:131], v[112:127]
    ds_read_b64_tr_b16 a[182:183], v29 offset:13312
    s_waitcnt vmcnt(10)
    s_barrier
    s_waitcnt lgkmcnt(6)
    v_mfma_f32_32x32x16_bf16 v[128:143], a[156:159], a[160:163], v[128:143]
    ds_read_b128 a[128:131], v22 offset:40960
    ds_read_b128 a[132:135], v30 offset:40960
    v_lshlrev_b32 v242, 10, v3
    v_lshl_add_u32 v242, v2, 4, v242
    buffer_load_dwordx4 v[232:235], v242, s[48:51], s11 offen
    v_mfma_f32_32x32x16_bf16 v[144:159], a[156:159], a[164:167], v[144:159]
    ds_read_b128 a[136:139], v30 offset:45056
    ds_read_b64_tr_b16 a[140:141], v26 offset:40960
    v_mfma_f32_32x32x16_bf16 v[64:79], a[168:171], a[156:159], v[64:79]
    ds_read_b64_tr_b16 a[142:143], v26 offset:41984
    ds_read_b64_tr_b16 a[144:145], v27 offset:40960
    buffer_load_dwordx4 v[236:239], v242, s[48:51], s11 offen offset:512
    s_waitcnt lgkmcnt(6)
    v_mfma_f32_32x32x16_bf16 v[80:95], a[172:175], a[156:159], v[80:95]
    ds_read_b64_tr_b16 a[146:147], v27 offset:41984
    ds_read_b64_tr_b16 a[148:149], v28 offset:40960
    v_mfma_f32_32x32x16_bf16 v[96:111], a[176:179], a[156:159], v[96:111]
    ds_read_b64_tr_b16 a[150:151], v28 offset:41984
    ds_read_b64_tr_b16 a[152:153], v29 offset:40960
    s_xor_b32 s3, s7, 3
    s_mul_i32 s89, s3, 229376
    s_lshl_b32 s3, s3, 7
    s_add_u32 s13, s3, s85
    s_add_u32 s12, s3, s84
    s_add_u32 s89, s89, s86
    s_add_u32 m0, s93, 122880
    s_nop 0
    buffer_load_dwordx4 v6, s[48:51], s12 offen offset:0 lds
    v_mfma_f32_32x32x16_bf16 v[112:127], a[180:183], a[156:159], v[112:127]
    ds_read_b64_tr_b16 a[154:155], v29 offset:41984
    s_waitcnt lgkmcnt(6)
    v_mfma_f32_32x32x16_bf16 v[128:143], a[128:131], a[132:135], v[128:143]
    ds_read_b128 a[156:159], v23 offset:40960
    ds_read_b128 a[160:163], v31 offset:40960
    buffer_load_dwordx4 v7, s[48:51], s12 offen offset:1024 lds
    v_mfma_f32_32x32x16_bf16 v[144:159], a[128:131], a[136:139], v[144:159]
    ds_read_b128 a[164:167], v31 offset:45056
    ds_read_b64_tr_b16 a[168:169], v26 offset:45056
    v_mfma_f32_32x32x16_bf16 v[64:79], a[140:143], a[128:131], v[64:79]
    ds_read_b64_tr_b16 a[170:171], v26 offset:46080
    ds_read_b64_tr_b16 a[172:173], v27 offset:45056
    buffer_load_dwordx4 v8, s[48:51], s12 offen offset:2048 lds
    s_waitcnt lgkmcnt(6)
    v_mfma_f32_32x32x16_bf16 v[80:95], a[144:147], a[128:131], v[80:95]
    ds_read_b64_tr_b16 a[174:175], v27 offset:46080
    ds_read_b64_tr_b16 a[176:177], v28 offset:45056
    v_mfma_f32_32x32x16_bf16 v[96:111], a[148:151], a[128:131], v[96:111]
    ds_read_b64_tr_b16 a[178:179], v28 offset:46080
    ds_read_b64_tr_b16 a[180:181], v29 offset:45056
    buffer_load_dwordx4 v9, s[48:51], s12 offen offset:3072 lds
    v_mfma_f32_32x32x16_bf16 v[112:127], a[152:155], a[128:131], v[112:127]
    ds_read_b64_tr_b16 a[182:183], v29 offset:46080
    s_waitcnt lgkmcnt(6)
    v_mfma_f32_32x32x16_bf16 v[128:143], a[156:159], a[160:163], v[128:143]
    ds_read_b128 a[128:131], v24 offset:40960
    ds_read_b128 a[132:135], v32 offset:40960
    s_lshr_b32 s3, s93, 1
    s_add_u32 m0, s3, 155648
    s_nop 0
    buffer_load_dwordx4 v10, s[56:59], s13 offen offset:0 lds
    v_mfma_f32_32x32x16_bf16 v[144:159], a[156:159], a[164:167], v[144:159]
    ds_read_b128 a[136:139], v32 offset:45056
    ds_read_b64_tr_b16 a[140:141], v26 offset:49152
    v_mfma_f32_32x32x16_bf16 v[64:79], a[168:171], a[156:159], v[64:79]
    ds_read_b64_tr_b16 a[142:143], v26 offset:50176
    ds_read_b64_tr_b16 a[144:145], v27 offset:49152
    buffer_load_dwordx4 v11, s[56:59], s13 offen offset:1024 lds
    s_waitcnt lgkmcnt(6)
    v_mfma_f32_32x32x16_bf16 v[80:95], a[172:175], a[156:159], v[80:95]
    ds_read_b64_tr_b16 a[146:147], v27 offset:50176
    ds_read_b64_tr_b16 a[148:149], v28 offset:49152
    v_mfma_f32_32x32x16_bf16 v[96:111], a[176:179], a[156:159], v[96:111]
    ds_read_b64_tr_b16 a[150:151], v28 offset:50176
    ds_read_b64_tr_b16 a[152:153], v29 offset:49152
    s_add_u32 m0, s93, 139264
    s_nop 0
    buffer_load_dwordx4 v14, s[52:55], s89 offen offset:0 lds
    v_mfma_f32_32x32x16_bf16 v[112:127], a[180:183], a[156:159], v[112:127]
    ds_read_b64_tr_b16 a[154:155], v29 offset:50176
    s_waitcnt lgkmcnt(6)
    v_mfma_f32_32x32x16_bf16 v[128:143], a[128:131], a[132:135], v[128:143]
    ds_read_b128 a[156:159], v25 offset:40960
    ds_read_b128 a[160:163], v33 offset:40960
    buffer_load_dwordx4 v15, s[52:55], s89 offen offset:1024 lds
    v_mfma_f32_32x32x16_bf16 v[144:159], a[128:131], a[136:139], v[144:159]
    ds_read_b128 a[164:167], v33 offset:45056
    ds_read_b64_tr_b16 a[168:169], v26 offset:53248
    v_mfma_f32_32x32x16_bf16 v[64:79], a[140:143], a[128:131], v[64:79]
    ds_read_b64_tr_b16 a[170:171], v26 offset:54272
    ds_read_b64_tr_b16 a[172:173], v27 offset:53248
    buffer_load_dwordx4 v16, s[52:55], s89 offen offset:2048 lds
    s_waitcnt lgkmcnt(6)
    v_mfma_f32_32x32x16_bf16 v[80:95], a[144:147], a[128:131], v[80:95]
    ds_read_b64_tr_b16 a[174:175], v27 offset:54272
    ds_read_b64_tr_b16 a[176:177], v28 offset:53248
    v_mfma_f32_32x32x16_bf16 v[96:111], a[148:151], a[128:131], v[96:111]
    ds_read_b64_tr_b16 a[178:179], v28 offset:54272
    ds_read_b64_tr_b16 a[180:181], v29 offset:53248
    buffer_load_dwordx4 v17, s[52:55], s89 offen offset:3072 lds
    v_mfma_f32_32x32x16_bf16 v[112:127], a[152:155], a[128:131], v[112:127]
    ds_read_b64_tr_b16 a[182:183], v29 offset:54272
    s_waitcnt vmcnt(12)
    s_barrier
    s_waitcnt lgkmcnt(6)
    v_mfma_f32_32x32x16_bf16 v[128:143], a[156:159], a[160:163], v[128:143]
    v_add_u32 v22, 0x14000, v22
    ds_read_b128 a[128:131], v22 offset:0
    v_add_u32 v30, 0x14000, v30
    ds_read_b128 a[132:135], v30 offset:0
    s_xor_b32 s3, s7, 4
    s_mul_i32 s89, s3, 229376
    s_lshl_b32 s3, s3, 7
    s_add_u32 s13, s3, s85
    s_add_u32 s12, s3, s84
    s_add_u32 s89, s89, s86
    s_add_u32 m0, s93, 0
    s_nop 0
    buffer_load_dwordx4 v6, s[48:51], s12 offen offset:0 lds
    v_mfma_f32_32x32x16_bf16 v[144:159], a[156:159], a[164:167], v[144:159]
    ds_read_b128 a[136:139], v30 offset:4096
    v_add_u32 v26, 0x14000, v26
    ds_read_b64_tr_b16 a[140:141], v26 offset:0
    v_mfma_f32_32x32x16_bf16 v[64:79], a[168:171], a[156:159], v[64:79]
    ds_read_b64_tr_b16 a[142:143], v26 offset:1024
    v_add_u32 v27, 0x14000, v27
    ds_read_b64_tr_b16 a[144:145], v27 offset:0
    buffer_load_dwordx4 v7, s[48:51], s12 offen offset:1024 lds
    s_waitcnt lgkmcnt(6)
    v_mfma_f32_32x32x16_bf16 v[80:95], a[172:175], a[156:159], v[80:95]
    ds_read_b64_tr_b16 a[146:147], v27 offset:1024
    v_add_u32 v28, 0x14000, v28
    ds_read_b64_tr_b16 a[148:149], v28 offset:0
    v_mfma_f32_32x32x16_bf16 v[96:111], a[176:179], a[156:159], v[96:111]
    ds_read_b64_tr_b16 a[150:151], v28 offset:1024
    v_add_u32 v29, 0x14000, v29
    ds_read_b64_tr_b16 a[152:153], v29 offset:0
    buffer_load_dwordx4 v8, s[48:51], s12 offen offset:2048 lds
    v_mfma_f32_32x32x16_bf16 v[112:127], a[180:183], a[156:159], v[112:127]
    ds_read_b64_tr_b16 a[154:155], v29 offset:1024
    s_waitcnt lgkmcnt(6)
    v_mfma_f32_32x32x16_bf16 v[128:143], a[128:131], a[132:135], v[128:143]
    v_add_u32 v23, 0x14000, v23
    ds_read_b128 a[156:159], v23 offset:0
    v_add_u32 v31, 0x14000, v31
    ds_read_b128 a[160:163], v31 offset:0
    buffer_load_dwordx4 v9, s[48:51], s12 offen offset:3072 lds
    v_mfma_f32_32x32x16_bf16 v[144:159], a[128:131], a[136:139], v[144:159]
    ds_read_b128 a[164:167], v31 offset:4096
    v_mfma_f32_32x32x16_bf16 v[64:79], a[140:143], a[128:131], v[64:79]
    ds_read_b64_tr_b16 a[168:169], v26 offset:4096
    ds_read_b64_tr_b16 a[170:171], v26 offset:5120
    s_lshr_b32 s3, s93, 1
    s_add_u32 m0, s3, 32768
    s_nop 0
    buffer_load_dwordx4 v10, s[56:59], s13 offen offset:0 lds
    s_waitcnt lgkmcnt(5)
    v_mfma_f32_32x32x16_bf16 v[80:95], a[144:147], a[128:131], v[80:95]
    ds_read_b64_tr_b16 a[172:173], v27 offset:4096
    ds_read_b64_tr_b16 a[174:175], v27 offset:5120
    v_mfma_f32_32x32x16_bf16 v[96:111], a[148:151], a[128:131], v[96:111]
    ds_read_b64_tr_b16 a[176:177], v28 offset:4096
    ds_read_b64_tr_b16 a[178:179], v28 offset:5120
    buffer_load_dwordx4 v11, s[56:59], s13 offen offset:1024 lds
    v_mfma_f32_32x32x16_bf16 v[112:127], a[152:155], a[128:131], v[112:127]
    ds_read_b64_tr_b16 a[180:181], v29 offset:4096
    ds_read_b64_tr_b16 a[182:183], v29 offset:5120
    s_waitcnt lgkmcnt(6)
    v_mfma_f32_32x32x16_bf16 v[128:143], a[156:159], a[160:163], v[128:143]
    v_add_u32 v24, 0x14000, v24
    ds_read_b128 a[128:131], v24 offset:0
    v_add_u32 v32, 0x14000, v32
    ds_read_b128 a[132:135], v32 offset:0
    v_mfma_f32_32x32x16_bf16 v[144:159], a[156:159], a[164:167], v[144:159]
    ds_read_b128 a[136:139], v32 offset:4096
    s_add_u32 m0, s93, 16384
    s_nop 0
    buffer_load_dwordx4 v14, s[52:55], s89 offen offset:0 lds
    v_mfma_f32_32x32x16_bf16 v[64:79], a[168:171], a[156:159], v[64:79]
    ds_read_b64_tr_b16 a[140:141], v26 offset:8192
    ds_read_b64_tr_b16 a[142:143], v26 offset:9216
    s_waitcnt lgkmcnt(5)
    v_mfma_f32_32x32x16_bf16 v[80:95], a[172:175], a[156:159], v[80:95]
    ds_read_b64_tr_b16 a[144:145], v27 offset:8192
    ds_read_b64_tr_b16 a[146:147], v27 offset:9216
    buffer_load_dwordx4 v15, s[52:55], s89 offen offset:1024 lds
    v_mfma_f32_32x32x16_bf16 v[96:111], a[176:179], a[156:159], v[96:111]
    ds_read_b64_tr_b16 a[148:149], v28 offset:8192
    ds_read_b64_tr_b16 a[150:151], v28 offset:9216
    v_mfma_f32_32x32x16_bf16 v[112:127], a[180:183], a[156:159], v[112:127]
    ds_read_b64_tr_b16 a[152:153], v29 offset:8192
    ds_read_b64_tr_b16 a[154:155], v29 offset:9216
    buffer_load_dwordx4 v16, s[52:55], s89 offen offset:2048 lds
    s_waitcnt lgkmcnt(6)
    v_mfma_f32_32x32x16_bf16 v[128:143], a[128:131], a[132:135], v[128:143]
    v_add_u32 v25, 0x14000, v25
    ds_read_b128 a[156:159], v25 offset:0
    v_add_u32 v33, 0x14000, v33
    ds_read_b128 a[160:163], v33 offset:0
    v_mfma_f32_32x32x16_bf16 v[144:159], a[128:131], a[136:139], v[144:159]
    ds_read_b128 a[164:167], v33 offset:4096
    buffer_load_dwordx4 v17, s[52:55], s89 offen offset:3072 lds
    v_mfma_f32_32x32x16_bf16 v[64:79], a[140:143], a[128:131], v[64:79]
    ds_read_b64_tr_b16 a[168:169], v26 offset:12288
    ds_read_b64_tr_b16 a[170:171], v26 offset:13312
    s_waitcnt lgkmcnt(5)
    v_mfma_f32_32x32x16_bf16 v[80:95], a[144:147], a[128:131], v[80:95]
    ds_read_b64_tr_b16 a[172:173], v27 offset:12288
    ds_read_b64_tr_b16 a[174:175], v27 offset:13312
    s_xor_b32 s14, s2, 0
    s_lshl_b32 s14, s14, 2
    s_add_u32 s14, s14, s6
    s_mul_i32 s3, s14, 1792
    v_lshrrev_b32 v246, 2, v1
    v_min_u32 v247, 13, v246
    v_lshlrev_b32 v247, 7, v247
    buffer_load_dword a255, v247, s[64:67], s3 offen
    v_mfma_f32_32x32x16_bf16 v[96:111], a[148:151], a[128:131], v[96:111]
    ds_read_b64_tr_b16 a[176:177], v28 offset:12288
    ds_read_b64_tr_b16 a[178:179], v28 offset:13312
    v_mfma_f32_32x32x16_bf16 v[112:127], a[152:155], a[128:131], v[112:127]
    ds_read_b64_tr_b16 a[180:181], v29 offset:12288
    ds_read_b64_tr_b16 a[182:183], v29 offset:13312
    s_waitcnt vmcnt(11)
    s_barrier
    s_waitcnt lgkmcnt(6)
    v_mfma_f32_32x32x16_bf16 v[128:143], a[156:159], a[160:163], v[128:143]
    ds_read_b128 a[128:131], v22 offset:40960
    ds_read_b128 a[132:135], v30 offset:40960
    s_xor_b32 s3, s7, 5
    s_mul_i32 s89, s3, 229376
    s_lshl_b32 s3, s3, 7
    s_add_u32 s13, s3, s85
    s_add_u32 s12, s3, s84
    s_add_u32 s89, s89, s86
    s_add_u32 m0, s93, 40960
    s_nop 0
    buffer_load_dwordx4 v6, s[48:51], s12 offen offset:0 lds
    v_mfma_f32_32x32x16_bf16 v[144:159], a[156:159], a[164:167], v[144:159]
    ds_read_b128 a[136:139], v30 offset:45056
    ds_read_b64_tr_b16 a[140:141], v26 offset:40960
    v_mov_b32 v228, 0
    v_mov_b32 v229, 0
    s_mov_b32 s15, 0x3f803f80
    v_mfma_f32_32x32x16_bf16 v[64:79], a[168:171], a[156:159], v[64:79]
    ds_read_b64_tr_b16 a[142:143], v26 offset:41984
    ds_read_b64_tr_b16 a[144:145], v27 offset:40960
    buffer_load_dwordx4 v7, s[48:51], s12 offen offset:1024 lds
    s_waitcnt lgkmcnt(6)
    v_mfma_f32_32x32x16_bf16 v[80:95], a[172:175], a[156:159], v[80:95]
    ds_read_b64_tr_b16 a[146:147], v27 offset:41984
    ds_read_b64_tr_b16 a[148:149], v28 offset:40960
    v_lshlrev_b32 v230, 16, v232
    v_and_b32 v231, 0xffff0000, v232
    v_add_f32 v228, v228, v230
    v_mfma_f32_32x32x16_bf16 v[96:111], a[176:179], a[156:159], v[96:111]
    ds_read_b64_tr_b16 a[150:151], v28 offset:41984
    ds_read_b64_tr_b16 a[152:153], v29 offset:40960
    buffer_load_dwordx4 v8, s[48:51], s12 offen offset:2048 lds
    v_mfma_f32_32x32x16_bf16 v[112:127], a[180:183], a[156:159], v[112:127]
    ds_read_b64_tr_b16 a[154:155], v29 offset:41984
    v_fmac_f32 v229, v230, v230
    v_add_f32 v228, v228, v231
    v_fmac_f32 v229, v231, v231
    s_waitcnt lgkmcnt(6)
    v_mfma_f32_32x32x16_bf16 v[128:143], a[128:131], a[132:135], v[128:143]
    ds_read_b128 a[156:159], v23 offset:40960
    ds_read_b128 a[160:163], v31 offset:40960
    buffer_load_dwordx4 v9, s[48:51], s12 offen offset:3072 lds
    v_mfma_f32_32x32x16_bf16 v[144:159], a[128:131], a[136:139], v[144:159]
    ds_read_b128 a[164:167], v31 offset:45056
    ds_read_b64_tr_b16 a[168:169], v26 offset:45056
    v_lshlrev_b32 v230, 16, v233
    v_and_b32 v231, 0xffff0000, v233
    v_add_f32 v228, v228, v230
    v_mfma_f32_32x32x16_bf16 v[64:79], a[140:143], a[128:131], v[64:79]
    ds_read_b64_tr_b16 a[170:171], v26 offset:46080
    ds_read_b64_tr_b16 a[172:173], v27 offset:45056
    s_lshr_b32 s3, s93, 1
    s_add_u32 m0, s3, 73728
    s_nop 0
    buffer_load_dwordx4 v10, s[56:59], s13 offen offset:0 lds
    s_waitcnt lgkmcnt(6)
    v_mfma_f32_32x32x16_bf16 v[80:95], a[144:147], a[128:131], v[80:95]
    ds_read_b64_tr_b16 a[174:175], v27 offset:46080
    ds_read_b64_tr_b16 a[176:177], v28 offset:45056
    v_fmac_f32 v229, v230, v230
    v_add_f32 v228, v228, v231
    v_fmac_f32 v229, v231, v231
    v_mfma_f32_32x32x16_bf16 v[96:111], a[148:151], a[128:131], v[96:111]
    ds_read_b64_tr_b16 a[178:179], v28 offset:46080
    ds_read_b64_tr_b16 a[180:181], v29 offset:45056
    buffer_load_dwordx4 v11, s[56:59], s13 offen offset:1024 lds
    v_mfma_f32_32x32x16_bf16 v[112:127], a[152:155], a[128:131], v[112:127]
    ds_read_b64_tr_b16 a[182:183], v29 offset:46080
    v_lshlrev_b32 v230, 16, v234
    v_and_b32 v231, 0xffff0000, v234
    v_add_f32 v228, v228, v230
    s_waitcnt lgkmcnt(6)
    v_mfma_f32_32x32x16_bf16 v[128:143], a[156:159], a[160:163], v[128:143]
    ds_read_b128 a[128:131], v24 offset:40960
    ds_read_b128 a[132:135], v32 offset:40960
    s_add_u32 m0, s93, 57344
    s_nop 0
    buffer_load_dwordx4 v14, s[52:55], s89 offen offset:0 lds
    v_mfma_f32_32x32x16_bf16 v[144:159], a[156:159], a[164:167], v[144:159]
    ds_read_b128 a[136:139], v32 offset:45056
    ds_read_b64_tr_b16 a[140:141], v26 offset:49152
    v_fmac_f32 v229, v230, v230
    v_add_f32 v228, v228, v231
    v_fmac_f32 v229, v231, v231
    v_mfma_f32_32x32x16_bf16 v[64:79], a[168:171], a[156:159], v[64:79]
    ds_read_b64_tr_b16 a[142:143], v26 offset:50176
    ds_read_b64_tr_b16 a[144:145], v27 offset:49152
    buffer_load_dwordx4 v15, s[52:55], s89 offen offset:1024 lds
    s_waitcnt lgkmcnt(6)
    v_mfma_f32_32x32x16_bf16 v[80:95], a[172:175], a[156:159], v[80:95]
    ds_read_b64_tr_b16 a[146:147], v27 offset:50176
    ds_read_b64_tr_b16 a[148:149], v28 offset:49152
    v_lshlrev_b32 v230, 16, v235
    v_and_b32 v231, 0xffff0000, v235
    v_add_f32 v228, v228, v230
    v_mfma_f32_32x32x16_bf16 v[96:111], a[176:179], a[156:159], v[96:111]
    ds_read_b64_tr_b16 a[150:151], v28 offset:50176
    ds_read_b64_tr_b16 a[152:153], v29 offset:49152
    buffer_load_dwordx4 v16, s[52:55], s89 offen offset:2048 lds
    v_mfma_f32_32x32x16_bf16 v[112:127], a[180:183], a[156:159], v[112:127]
    ds_read_b64_tr_b16 a[154:155], v29 offset:50176
    v_fmac_f32 v229, v230, v230
    v_add_f32 v228, v228, v231
    v_fmac_f32 v229, v231, v231
    s_waitcnt lgkmcnt(6)
    v_mfma_f32_32x32x16_bf16 v[128:143], a[128:131], a[132:135], v[128:143]
    ds_read_b128 a[156:159], v25 offset:40960
    ds_read_b128 a[160:163], v33 offset:40960
    buffer_load_dwordx4 v17, s[52:55], s89 offen offset:3072 lds
    v_mfma_f32_32x32x16_bf16 v[144:159], a[128:131], a[136:139], v[144:159]
    ds_read_b128 a[164:167], v33 offset:45056
    ds_read_b64_tr_b16 a[168:169], v26 offset:53248
    v_lshlrev_b32 v230, 16, v236
    v_and_b32 v231, 0xffff0000, v236
    v_add_f32 v228, v228, v230
    v_mfma_f32_32x32x16_bf16 v[64:79], a[140:143], a[128:131], v[64:79]
    ds_read_b64_tr_b16 a[170:171], v26 offset:54272
    ds_read_b64_tr_b16 a[172:173], v27 offset:53248
    s_lshl_b32 s14, s2, 2
    s_add_u32 s14, s14, s6
    s_lshl_b32 s14, s14, 9
    v_and_b32 v246, 3, v246
    v_lshlrev_b32 v246, 7, v246
    buffer_load_dword a255, v246, s[68:71], s14 offen
    s_waitcnt lgkmcnt(6)
    v_mfma_f32_32x32x16_bf16 v[80:95], a[144:147], a[128:131], v[80:95]
    ds_read_b64_tr_b16 a[174:175], v27 offset:54272
    ds_read_b64_tr_b16 a[176:177], v28 offset:53248
    v_fmac_f32 v229, v230, v230
    v_add_f32 v228, v228, v231
    v_fmac_f32 v229, v231, v231
    v_mfma_f32_32x32x16_bf16 v[96:111], a[148:151], a[128:131], v[96:111]
    ds_read_b64_tr_b16 a[178:179], v28 offset:54272
    ds_read_b64_tr_b16 a[180:181], v29 offset:53248
    s_lshl_b32 s14, s2, 2
    s_add_u32 s14, s14, s6
    s_lshl_b32 s14, s14, 9
    buffer_load_dword a255, v246, s[72:75], s14 offen
    v_mfma_f32_32x32x16_bf16 v[112:127], a[152:155], a[128:131], v[112:127]
    ds_read_b64_tr_b16 a[182:183], v29 offset:54272
    v_lshlrev_b32 v230, 16, v237
    v_and_b32 v231, 0xffff0000, v237
    v_add_f32 v228, v228, v230
    s_waitcnt vmcnt(13)
    s_barrier
    s_waitcnt lgkmcnt(6)
    v_mfma_f32_32x32x16_bf16 v[128:143], a[156:159], a[160:163], v[128:143]
    v_add_u32 v22, 0xfffec000, v22
    ds_read_b128 a[128:131], v22 offset:0
    v_add_u32 v30, 0xfffec000, v30
    ds_read_b128 a[132:135], v30 offset:0
    s_nop 0
    v_fmac_f32 v229, v230, v230
    v_mfma_f32_32x32x16_bf16 v[144:159], a[156:159], a[164:167], v[144:159]
    ds_read_b128 a[136:139], v30 offset:4096
    v_add_u32 v26, 0xfffec000, v26
    ds_read_b64_tr_b16 a[140:141], v26 offset:0
    v_add_f32 v228, v228, v231
    v_fmac_f32 v229, v231, v231
    v_mfma_f32_32x32x16_bf16 v[64:79], a[168:171], a[156:159], v[64:79]
    ds_read_b64_tr_b16 a[142:143], v26 offset:1024
    v_add_u32 v27, 0xfffec000, v27
    ds_read_b64_tr_b16 a[144:145], v27 offset:0
    s_xor_b32 s3, s7, 6
    s_mul_i32 s89, s3, 229376
    s_lshl_b32 s3, s3, 7
    s_add_u32 s13, s3, s85
    s_add_u32 s12, s3, s84
    s_add_u32 s89, s89, s86
    s_add_u32 m0, s93, 81920
    s_nop 0
    buffer_load_dwordx4 v6, s[48:51], s12 offen offset:0 lds
    s_waitcnt lgkmcnt(6)
    v_mfma_f32_32x32x16_bf16 v[80:95], a[172:175], a[156:159], v[80:95]
    ds_read_b64_tr_b16 a[146:147], v27 offset:1024
    v_add_u32 v28, 0xfffec000, v28
    ds_read_b64_tr_b16 a[148:149], v28 offset:0
    v_lshlrev_b32 v230, 16, v238
    v_and_b32 v231, 0xffff0000, v238
    v_mfma_f32_32x32x16_bf16 v[96:111], a[176:179], a[156:159], v[96:111]
    ds_read_b64_tr_b16 a[150:151], v28 offset:1024
    v_add_u32 v29, 0xfffec000, v29
    ds_read_b64_tr_b16 a[152:153], v29 offset:0
    buffer_load_dwordx4 v7, s[48:51], s12 offen offset:1024 lds
    v_mfma_f32_32x32x16_bf16 v[112:127], a[180:183], a[156:159], v[112:127]
    ds_read_b64_tr_b16 a[154:155], v29 offset:1024
    v_add_f32 v228, v228, v230
    v_fmac_f32 v229, v230, v230
    v_add_f32 v228, v228, v231
    s_waitcnt lgkmcnt(6)
    v_mfma_f32_32x32x16_bf16 v[128:143], a[128:131], a[132:135], v[128:143]
    v_add_u32 v23, 0xfffec000, v23
    ds_read_b128 a[156:159], v23 offset:0
    v_add_u32 v31, 0xfffec000, v31
    ds_read_b128 a[160:163], v31 offset:0
    buffer_load_dwordx4 v8, s[48:51], s12 offen offset:2048 lds
    v_mfma_f32_32x32x16_bf16 v[144:159], a[128:131], a[136:139], v[144:159]
    ds_read_b128 a[164:167], v31 offset:4096
    v_fmac_f32 v229, v231, v231
    v_lshlrev_b32 v230, 16, v239
    v_and_b32 v231, 0xffff0000, v239
    v_add_f32 v228, v228, v230
    v_mfma_f32_32x32x16_bf16 v[64:79], a[140:143], a[128:131], v[64:79]
    ds_read_b64_tr_b16 a[168:169], v26 offset:4096
    ds_read_b64_tr_b16 a[170:171], v26 offset:5120
    buffer_load_dwordx4 v9, s[48:51], s12 offen offset:3072 lds
    s_waitcnt lgkmcnt(5)
    v_mfma_f32_32x32x16_bf16 v[80:95], a[144:147], a[128:131], v[80:95]
    ds_read_b64_tr_b16 a[172:173], v27 offset:4096
    ds_read_b64_tr_b16 a[174:175], v27 offset:5120
    v_fmac_f32 v229, v230, v230
    v_add_f32 v228, v228, v231
    v_fmac_f32 v229, v231, v231
    v_mfma_f32_32x32x16_bf16 v[96:111], a[148:151], a[128:131], v[96:111]
    ds_read_b64_tr_b16 a[176:177], v28 offset:4096
    ds_read_b64_tr_b16 a[178:179], v28 offset:5120
    s_lshr_b32 s3, s93, 1
    s_add_u32 m0, s3, 114688
    s_nop 0
    buffer_load_dwordx4 v10, s[56:59], s13 offen offset:0 lds
    v_mfma_f32_32x32x16_bf16 v[112:127], a[152:155], a[128:131], v[112:127]
    ds_read_b64_tr_b16 a[180:181], v29 offset:4096
    ds_read_b64_tr_b16 a[182:183], v29 offset:5120
    v_add_f32_dpp v228, v228, v228 row_ror:8 row_mask:0xf bank_mask:0xf
    v_add_f32_dpp v229, v229, v229 row_ror:8 row_mask:0xf bank_mask:0xf
    s_waitcnt lgkmcnt(6)
    v_mfma_f32_32x32x16_bf16 v[128:143], a[156:159], a[160:163], v[128:143]
    v_add_u32 v24, 0xfffec000, v24
    ds_read_b128 a[128:131], v24 offset:0
    v_add_u32 v32, 0xfffec000, v32
    ds_read_b128 a[132:135], v32 offset:0
    v_add_f32_dpp v228, v228, v228 row_ror:4 row_mask:0xf bank_mask:0xf
    v_mfma_f32_32x32x16_bf16 v[144:159], a[156:159], a[164:167], v[144:159]
    ds_read_b128 a[136:139], v32 offset:4096
    buffer_load_dwordx4 v11, s[56:59], s13 offen offset:1024 lds
    v_add_f32_dpp v229, v229, v229 row_ror:4 row_mask:0xf bank_mask:0xf
    v_mfma_f32_32x32x16_bf16 v[64:79], a[168:171], a[156:159], v[64:79]
    ds_read_b64_tr_b16 a[140:141], v26 offset:8192
    ds_read_b64_tr_b16 a[142:143], v26 offset:9216
    v_add_f32_dpp v228, v228, v228 row_ror:2 row_mask:0xf bank_mask:0xf
    v_add_f32_dpp v229, v229, v229 row_ror:2 row_mask:0xf bank_mask:0xf
    s_waitcnt lgkmcnt(5)
    v_mfma_f32_32x32x16_bf16 v[80:95], a[172:175], a[156:159], v[80:95]
    ds_read_b64_tr_b16 a[144:145], v27 offset:8192
    ds_read_b64_tr_b16 a[146:147], v27 offset:9216
    s_add_u32 m0, s93, 98304
    s_nop 0
    buffer_load_dwordx4 v14, s[52:55], s89 offen offset:0 lds
    v_mfma_f32_32x32x16_bf16 v[96:111], a[176:179], a[156:159], v[96:111]
    ds_read_b64_tr_b16 a[148:149], v28 offset:8192
    ds_read_b64_tr_b16 a[150:151], v28 offset:9216
    v_add_f32_dpp v228, v228, v228 row_ror:1 row_mask:0xf bank_mask:0xf
    v_add_f32_dpp v229, v229, v229 row_ror:1 row_mask:0xf bank_mask:0xf
    v_mov_b32 v230, v228
    v_mfma_f32_32x32x16_bf16 v[112:127], a[180:183], a[156:159], v[112:127]
    ds_read_b64_tr_b16 a[152:153], v29 offset:8192
    ds_read_b64_tr_b16 a[154:155], v29 offset:9216
    buffer_load_dwordx4 v15, s[52:55], s89 offen offset:1024 lds
    s_waitcnt lgkmcnt(6)
    v_mfma_f32_32x32x16_bf16 v[128:143], a[128:131], a[132:135], v[128:143]
    v_add_u32 v25, 0xfffec000, v25
    ds_read_b128 a[156:159], v25 offset:0
    v_add_u32 v33, 0xfffec000, v33
    ds_read_b128 a[160:163], v33 offset:0
    v_mov_b32 v231, v229
    v_mfma_f32_32x32x16_bf16 v[144:159], a[128:131], a[136:139], v[144:159]
    ds_read_b128 a[164:167], v33 offset:4096
    buffer_load_dwordx4 v16, s[52:55], s89 offen offset:2048 lds
    v_permlane16_swap_b32 v228, v230
    v_mfma_f32_32x32x16_bf16 v[64:79], a[140:143], a[128:131], v[64:79]
    ds_read_b64_tr_b16 a[168:169], v26 offset:12288
    ds_read_b64_tr_b16 a[170:171], v26 offset:13312
    v_permlane16_swap_b32 v229, v231
    v_add_f32 v228, v228, v230
    s_waitcnt lgkmcnt(5)
    v_mfma_f32_32x32x16_bf16 v[80:95], a[144:147], a[128:131], v[80:95]
    ds_read_b64_tr_b16 a[172:173], v27 offset:12288
    ds_read_b64_tr_b16 a[174:175], v27 offset:13312
    buffer_load_dwordx4 v17, s[52:55], s89 offen offset:3072 lds
    v_mfma_f32_32x32x16_bf16 v[96:111], a[148:151], a[128:131], v[96:111]
    ds_read_b64_tr_b16 a[176:177], v28 offset:12288
    ds_read_b64_tr_b16 a[178:179], v28 offset:13312
    v_add_f32 v229, v229, v231
    v_mul_f32 v228, 0x3b000000, v228
    v_mul_f32 v229, 0x3b000000, v229
    v_mfma_f32_32x32x16_bf16 v[112:127], a[152:155], a[128:131], v[112:127]
    ds_read_b64_tr_b16 a[180:181], v29 offset:12288
    ds_read_b64_tr_b16 a[182:183], v29 offset:13312
    v_fma_f32 v229, -v228, v228, v229
    v_max_f32 v229, 0, v229
    s_waitcnt vmcnt(12)
    s_barrier
    s_waitcnt lgkmcnt(6)
    v_mfma_f32_32x32x16_bf16 v[128:143], a[156:159], a[160:163], v[128:143]
    ds_read_b128 a[128:131], v22 offset:40960
    ds_read_b128 a[132:135], v30 offset:40960
    s_xor_b32 s3, s7, 7
    s_mul_i32 s89, s3, 229376
    s_lshl_b32 s3, s3, 7
    s_add_u32 s13, s3, s85
    s_add_u32 s12, s3, s84
    s_add_u32 s89, s89, s86
    s_add_u32 m0, s93, 122880
    s_nop 0
    buffer_load_dwordx4 v6, s[48:51], s12 offen offset:0 lds
    v_mfma_f32_32x32x16_bf16 v[144:159], a[156:159], a[164:167], v[144:159]
    ds_read_b128 a[136:139], v30 offset:45056
    ds_read_b64_tr_b16 a[140:141], v26 offset:40960
    v_cvt_pk_bf16_f32 v229, v229, v229
    v_and_b32 v229, 0xffff0000, v229
    v_add_f32 v229, 0x3727c5ac, v229
    v_mfma_f32_32x32x16_bf16 v[64:79], a[168:171], a[156:159], v[64:79]
    ds_read_b64_tr_b16 a[142:143], v26 offset:41984
    ds_read_b64_tr_b16 a[144:145], v27 offset:40960
    buffer_load_dwordx4 v7, s[48:51], s12 offen offset:1024 lds
    s_waitcnt lgkmcnt(6)
    v_mfma_f32_32x32x16_bf16 v[80:95], a[172:175], a[156:159], v[80:95]
    ds_read_b64_tr_b16 a[146:147], v27 offset:41984
    ds_read_b64_tr_b16 a[148:149], v28 offset:40960
    v_cvt_pk_bf16_f32 v229, v229, v229
    v_and_b32 v229, 0xffff0000, v229
    v_sqrt_f32 v229, v229
    v_mfma_f32_32x32x16_bf16 v[96:111], a[176:179], a[156:159], v[96:111]
    ds_read_b64_tr_b16 a[150:151], v28 offset:41984
    ds_read_b64_tr_b16 a[152:153], v29 offset:40960
    buffer_load_dwordx4 v8, s[48:51], s12 offen offset:2048 lds
    v_mfma_f32_32x32x16_bf16 v[112:127], a[180:183], a[156:159], v[112:127]
    ds_read_b64_tr_b16 a[154:155], v29 offset:41984
    v_cvt_pk_bf16_f32 v232, v228, v229
    v_mov_b32 v233, s10
    v_lshlrev_b32 v230, 3, v3
    s_lshr_b32 s11, s11, 7
    s_waitcnt lgkmcnt(6)
    v_mfma_f32_32x32x16_bf16 v[128:143], a[128:131], a[132:135], v[128:143]
    ds_read_b128 a[156:159], v23 offset:40960
    ds_read_b128 a[160:163], v31 offset:40960
    s_add_u32 s11, s11, 65536
    s_mov_b32 exec_lo, 1
    s_mov_b32 exec_hi, 1
    buffer_store_dwordx2 v[232:233], v230, s[76:79], s11 offen sc1
    s_mov_b64 exec, -1
    v_mfma_f32_32x32x16_bf16 v[144:159], a[128:131], a[136:139], v[144:159]
    ds_read_b128 a[164:167], v31 offset:45056
    ds_read_b64_tr_b16 a[168:169], v26 offset:45056
    buffer_load_dwordx4 v9, s[48:51], s12 offen offset:3072 lds
    v_mfma_f32_32x32x16_bf16 v[64:79], a[140:143], a[128:131], v[64:79]
    ds_read_b64_tr_b16 a[170:171], v26 offset:46080
    ds_read_b64_tr_b16 a[172:173], v27 offset:45056
    s_waitcnt lgkmcnt(6)
    v_mfma_f32_32x32x16_bf16 v[80:95], a[144:147], a[128:131], v[80:95]
    ds_read_b64_tr_b16 a[174:175], v27 offset:46080
    ds_read_b64_tr_b16 a[176:177], v28 offset:45056
    s_lshr_b32 s3, s93, 1
    s_add_u32 m0, s3, 155648
    s_nop 0
    buffer_load_dwordx4 v10, s[56:59], s13 offen offset:0 lds
    v_mfma_f32_32x32x16_bf16 v[96:111], a[148:151], a[128:131], v[96:111]
    ds_read_b64_tr_b16 a[178:179], v28 offset:46080
    ds_read_b64_tr_b16 a[180:181], v29 offset:45056
    v_mfma_f32_32x32x16_bf16 v[112:127], a[152:155], a[128:131], v[112:127]
    ds_read_b64_tr_b16 a[182:183], v29 offset:46080
    s_waitcnt lgkmcnt(6)
    v_mfma_f32_32x32x16_bf16 v[128:143], a[156:159], a[160:163], v[128:143]
    ds_read_b128 a[128:131], v24 offset:40960
    ds_read_b128 a[132:135], v32 offset:40960
    buffer_load_dwordx4 v11, s[56:59], s13 offen offset:1024 lds
    v_mfma_f32_32x32x16_bf16 v[144:159], a[156:159], a[164:167], v[144:159]
    ds_read_b128 a[136:139], v32 offset:45056
    ds_read_b64_tr_b16 a[140:141], v26 offset:49152
    v_mfma_f32_32x32x16_bf16 v[64:79], a[168:171], a[156:159], v[64:79]
    ds_read_b64_tr_b16 a[142:143], v26 offset:50176
    ds_read_b64_tr_b16 a[144:145], v27 offset:49152
    s_add_u32 m0, s93, 139264
    s_nop 0
    buffer_load_dwordx4 v14, s[52:55], s89 offen offset:0 lds
    s_waitcnt lgkmcnt(6)
    v_mfma_f32_32x32x16_bf16 v[80:95], a[172:175], a[156:159], v[80:95]
    ds_read_b64_tr_b16 a[146:147], v27 offset:50176
    ds_read_b64_tr_b16 a[148:149], v28 offset:49152
    v_mfma_f32_32x32x16_bf16 v[96:111], a[176:179], a[156:159], v[96:111]
    ds_read_b64_tr_b16 a[150:151], v28 offset:50176
    ds_read_b64_tr_b16 a[152:153], v29 offset:49152
    buffer_load_dwordx4 v15, s[52:55], s89 offen offset:1024 lds
    v_mfma_f32_32x32x16_bf16 v[112:127], a[180:183], a[156:159], v[112:127]
    ds_read_b64_tr_b16 a[154:155], v29 offset:50176
    s_waitcnt lgkmcnt(6)
    v_mfma_f32_32x32x16_bf16 v[128:143], a[128:131], a[132:135], v[128:143]
    ds_read_b128 a[156:159], v25 offset:40960
    ds_read_b128 a[160:163], v33 offset:40960
    v_mfma_f32_32x32x16_bf16 v[144:159], a[128:131], a[136:139], v[144:159]
    ds_read_b128 a[164:167], v33 offset:45056
    ds_read_b64_tr_b16 a[168:169], v26 offset:53248
    buffer_load_dwordx4 v16, s[52:55], s89 offen offset:2048 lds
    v_mfma_f32_32x32x16_bf16 v[64:79], a[140:143], a[128:131], v[64:79]
    ds_read_b64_tr_b16 a[170:171], v26 offset:54272
    ds_read_b64_tr_b16 a[172:173], v27 offset:53248
    s_waitcnt lgkmcnt(6)
    v_mfma_f32_32x32x16_bf16 v[80:95], a[144:147], a[128:131], v[80:95]
    ds_read_b64_tr_b16 a[174:175], v27 offset:54272
    ds_read_b64_tr_b16 a[176:177], v28 offset:53248
    buffer_load_dwordx4 v17, s[52:55], s89 offen offset:3072 lds
    v_mfma_f32_32x32x16_bf16 v[96:111], a[148:151], a[128:131], v[96:111]
    ds_read_b64_tr_b16 a[178:179], v28 offset:54272
    ds_read_b64_tr_b16 a[180:181], v29 offset:53248
    v_mfma_f32_32x32x16_bf16 v[112:127], a[152:155], a[128:131], v[112:127]
    ds_read_b64_tr_b16 a[182:183], v29 offset:54272
    s_waitcnt vmcnt(11)
    s_barrier
    s_waitcnt lgkmcnt(6)
    v_mfma_f32_32x32x16_bf16 v[128:143], a[156:159], a[160:163], v[128:143]
    v_add_u32 v22, 0x14000, v22
    ds_read_b128 a[128:131], v22 offset:0
    v_add_u32 v30, 0x14000, v30
    ds_read_b128 a[132:135], v30 offset:0
    s_add_u32 s12, s18, 0
    s_add_u32 m0, s94, 0
    s_nop 0
    buffer_load_dwordx4 v18, s[64:67], s12 offen offset:0 lds
    v_mfma_f32_32x32x16_bf16 v[144:159], a[156:159], a[164:167], v[144:159]
    ds_read_b128 a[136:139], v30 offset:4096
    v_add_u32 v26, 0x14000, v26
    ds_read_b64_tr_b16 a[140:141], v26 offset:0
    s_lshl_b32 s3, s6, 2
    s_sub_u32 s3, s4, s3
    s_sub_u32 s3, s3, 1
    v_sub_u32 v6, s3, v3
    v_subrev_u32 v7, 2, v6
    v_mfma_f32_32x32x16_bf16 v[64:79], a[168:171], a[156:159], v[64:79]
    ds_read_b64_tr_b16 a[142:143], v26 offset:1024
    v_add_u32 v27, 0x14000, v27
    ds_read_b64_tr_b16 a[144:145], v27 offset:0
    v_ashrrev_i32 v8, 31, v6
    s_waitcnt lgkmcnt(6)
    v_mfma_f32_32x32x16_bf16 v[80:95], a[172:175], a[156:159], v[80:95]
    ds_read_b64_tr_b16 a[146:147], v27 offset:1024
    v_add_u32 v28, 0x14000, v28
    ds_read_b64_tr_b16 a[148:149], v28 offset:0
    buffer_load_dwordx4 v19, s[64:67], s12 offen offset:1024 lds
    v_mfma_f32_32x32x16_bf16 v[96:111], a[176:179], a[156:159], v[96:111]
    ds_read_b64_tr_b16 a[150:151], v28 offset:1024
    v_add_u32 v29, 0x14000, v29
    ds_read_b64_tr_b16 a[152:153], v29 offset:0
    v_ashrrev_i32 v9, 31, v7
    v_bfi_b32 v8, v8, 0, s10
    v_mfma_f32_32x32x16_bf16 v[112:127], a[180:183], a[156:159], v[112:127]
    ds_read_b64_tr_b16 a[154:155], v29 offset:1024
    v_bfi_b32 v9, v9, 0, s10
    v_lshlrev_b32 v240, 4, v2
    v_lshl_add_u32 v6, v6, 9, v240
    s_waitcnt lgkmcnt(6)
    v_mfma_f32_32x32x16_bf16 v[128:143], a[128:131], a[132:135], v[128:143]
    v_add_u32 v23, 0x14000, v23
    ds_read_b128 a[156:159], v23 offset:0
    v_add_u32 v31, 0x14000, v31
    ds_read_b128 a[160:163], v31 offset:0
    buffer_load_dwordx4 v20, s[64:67], s12 offen offset:2048 lds
    v_mfma_f32_32x32x16_bf16 v[144:159], a[128:131], a[136:139], v[144:159]
    ds_read_b128 a[164:167], v31 offset:4096
    v_lshl_add_u32 v7, v7, 9, v240
    s_lshr_b32 s3, s93, 3
    s_add_u32 s3, s3, 33792
    v_lshl_add_u32 v16, v1, 3, s3
    v_lshlrev_b32 v17, 3, v2
    v_add_u32 v17, 33792, v17
    v_mfma_f32_32x32x16_bf16 v[64:79], a[140:143], a[128:131], v[64:79]
    ds_read_b64_tr_b16 a[168:169], v26 offset:4096
    ds_read_b64_tr_b16 a[170:171], v26 offset:5120
    s_lshr_b32 s3, s6, 1
    s_mul_i32 s3, s3, 32768
    s_add_u32 s3, s3, s93
    s_add_u32 s89, s3, 73728
    v_lshlrev_b32 v14, 5, v3
    s_waitcnt lgkmcnt(5)
    v_mfma_f32_32x32x16_bf16 v[80:95], a[144:147], a[128:131], v[80:95]
    ds_read_b64_tr_b16 a[172:173], v27 offset:4096
    ds_read_b64_tr_b16 a[174:175], v27 offset:5120
    buffer_load_dwordx4 v21, s[64:67], s12 offen offset:3072 lds
    v_mfma_f32_32x32x16_bf16 v[96:111], a[148:151], a[128:131], v[96:111]
    ds_read_b64_tr_b16 a[176:177], v28 offset:4096
    ds_read_b64_tr_b16 a[178:179], v28 offset:5120
    v_lshl_add_u32 v14, v2, 6, v14
    v_add_u32 v14, s89, v14
    v_bfe_u32 v15, v1, 2, 2
    v_mfma_f32_32x32x16_bf16 v[112:127], a[152:155], a[128:131], v[112:127]
    ds_read_b64_tr_b16 a[180:181], v29 offset:4096
    ds_read_b64_tr_b16 a[182:183], v29 offset:5120
    v_lshl_add_u32 v15, v3, 3, v15
    v_lshlrev_b32 v15, 6, v15
    s_waitcnt lgkmcnt(6)
    v_mfma_f32_32x32x16_bf16 v[128:143], a[156:159], a[160:163], v[128:143]
    v_add_u32 v24, 0x14000, v24
    ds_read_b128 a[128:131], v24 offset:0
    v_add_u32 v32, 0x14000, v32
    ds_read_b128 a[132:135], v32 offset:0
    s_add_u32 m0, m0, 4096
    s_xor_b32 s12, s12, 32768
    buffer_load_dwordx4 v18, s[64:67], s12 offen offset:0 lds
    v_mfma_f32_32x32x16_bf16 v[144:159], a[156:159], a[164:167], v[144:159]
    ds_read_b128 a[136:139], v32 offset:4096
    v_and_b32 v240, 1, v1
    v_lshl_add_u32 v15, v240, 5, v15
    v_bfe_u32 v240, v1, 1, 1
    v_lshl_add_u32 v15, v240, 3, v15
    v_mfma_f32_32x32x16_bf16 v[64:79], a[168:171], a[156:159], v[64:79]
    ds_read_b64_tr_b16 a[140:141], v26 offset:8192
    ds_read_b64_tr_b16 a[142:143], v26 offset:9216
    v_bfe_u32 v240, v1, 4, 1
    v_lshl_add_u32 v15, v240, 4, v15
    s_waitcnt lgkmcnt(5)
    v_mfma_f32_32x32x16_bf16 v[80:95], a[172:175], a[156:159], v[80:95]
    ds_read_b64_tr_b16 a[144:145], v27 offset:8192
    ds_read_b64_tr_b16 a[146:147], v27 offset:9216
    buffer_load_dwordx4 v19, s[64:67], s12 offen offset:1024 lds
    v_mfma_f32_32x32x16_bf16 v[96:111], a[176:179], a[156:159], v[96:111]
    ds_read_b64_tr_b16 a[148:149], v28 offset:8192
    ds_read_b64_tr_b16 a[150:151], v28 offset:9216
    v_add_u32 v15, s89, v15
    s_lshr_b32 s3, s5, 2
    s_lshl_b32 s3, s3, 3
    s_and_b32 s89, s5, 3
    s_add_u32 s3, s3, s89
    s_lshl_b32 s3, s3, 11
    s_add_u32 s89, s91, s3
    s_add_u32 s89, s89, 114688
    v_mfma_f32_32x32x16_bf16 v[112:127], a[180:183], a[156:159], v[112:127]
    ds_read_b64_tr_b16 a[152:153], v29 offset:8192
    ds_read_b64_tr_b16 a[154:155], v29 offset:9216
    s_lshl_b32 s3, s8, 1
    s_lshr_b32 s96, s6, 1
    s_add_u32 s96, s3, s96
    s_xor_b32 s88, s96, 1
    s_mul_i32 s96, s96, 180224
    s_mul_i32 s88, s88, 180224
    s_add_u32 s96, s96, 1048576
    s_add_u32 s88, s88, 1048576
    s_waitcnt lgkmcnt(6)
    v_mfma_f32_32x32x16_bf16 v[128:143], a[128:131], a[132:135], v[128:143]
    v_add_u32 v25, 0x14000, v25
    ds_read_b128 a[156:159], v25 offset:0
    v_add_u32 v33, 0x14000, v33
    ds_read_b128 a[160:163], v33 offset:0
    buffer_load_dwordx4 v20, s[64:67], s12 offen offset:2048 lds
    v_mfma_f32_32x32x16_bf16 v[144:159], a[128:131], a[136:139], v[144:159]
    ds_read_b128 a[164:167], v33 offset:4096
    v_mfma_f32_32x32x16_bf16 v[64:79], a[140:143], a[128:131], v[64:79]
    ds_read_b64_tr_b16 a[168:169], v26 offset:12288
    ds_read_b64_tr_b16 a[170:171], v26 offset:13312
    s_waitcnt lgkmcnt(5)
    v_mfma_f32_32x32x16_bf16 v[80:95], a[144:147], a[128:131], v[80:95]
    ds_read_b64_tr_b16 a[172:173], v27 offset:12288
    ds_read_b64_tr_b16 a[174:175], v27 offset:13312
    buffer_load_dwordx4 v21, s[64:67], s12 offen offset:3072 lds
    v_mfma_f32_32x32x16_bf16 v[96:111], a[148:151], a[128:131], v[96:111]
    ds_read_b64_tr_b16 a[176:177], v28 offset:12288
    ds_read_b64_tr_b16 a[178:179], v28 offset:13312
    v_mfma_f32_32x32x16_bf16 v[112:127], a[152:155], a[128:131], v[112:127]
    ds_read_b64_tr_b16 a[180:181], v29 offset:12288
    ds_read_b64_tr_b16 a[182:183], v29 offset:13312
    s_waitcnt vmcnt(8)
    s_barrier
    s_waitcnt lgkmcnt(6)
    v_mfma_f32_32x32x16_bf16 v[128:143], a[156:159], a[160:163], v[128:143]
    ds_read_b128 a[128:131], v22 offset:40960
    ds_read_b128 a[132:135], v30 offset:40960
    s_lshr_b32 s14, s84, 7
    s_add_u32 s14, s14, 65536
    v_lshlrev_b32 v244, 3, v5
    buffer_load_dwordx2 v[228:229], v244, s[76:79], s14 offen sc1
    v_mfma_f32_32x32x16_bf16 v[144:159], a[156:159], a[164:167], v[144:159]
    ds_read_b128 a[136:139], v30 offset:45056
    ds_read_b64_tr_b16 a[140:141], v26 offset:40960
    v_mfma_f32_32x32x16_bf16 v[64:79], a[168:171], a[156:159], v[64:79]
    ds_read_b64_tr_b16 a[142:143], v26 offset:41984
    ds_read_b64_tr_b16 a[144:145], v27 offset:40960
    s_lshl_b32 s14, s5, 8
    s_add_u32 s14, s14, 210944
    v_lshlrev_b32 v244, 12, v3
    v_lshl_add_u32 v244, v2, 3, v244
    buffer_load_dwordx2 v[208:209], v244, s[76:79], s14 offen sc1
    s_waitcnt lgkmcnt(6)
    v_mfma_f32_32x32x16_bf16 v[80:95], a[172:175], a[156:159], v[80:95]
    ds_read_b64_tr_b16 a[146:147], v27 offset:41984
    ds_read_b64_tr_b16 a[148:149], v28 offset:40960
    v_mfma_f32_32x32x16_bf16 v[96:111], a[176:179], a[156:159], v[96:111]
    ds_read_b64_tr_b16 a[150:151], v28 offset:41984
    ds_read_b64_tr_b16 a[152:153], v29 offset:40960
    s_lshl_b32 s14, s97, 10
    s_add_u32 s14, s14, 196608
    v_lshlrev_b32 v244, 3, v1
    buffer_load_dwordx2 v[200:201], v244, s[76:79], s14 offen sc1
    v_mfma_f32_32x32x16_bf16 v[112:127], a[180:183], a[156:159], v[112:127]
    ds_read_b64_tr_b16 a[154:155], v29 offset:41984
    s_waitcnt lgkmcnt(6)
    v_mfma_f32_32x32x16_bf16 v[128:143], a[128:131], a[132:135], v[128:143]
    ds_read_b128 a[156:159], v23 offset:40960
    ds_read_b128 a[160:163], v31 offset:40960
    buffer_load_dwordx2 v[204:205], v244, s[76:79], s14 offen offset:512 sc1
    v_mfma_f32_32x32x16_bf16 v[144:159], a[128:131], a[136:139], v[144:159]
    ds_read_b128 a[164:167], v31 offset:45056
    ds_read_b64_tr_b16 a[168:169], v26 offset:45056
    v_mfma_f32_32x32x16_bf16 v[64:79], a[140:143], a[128:131], v[64:79]
    ds_read_b64_tr_b16 a[170:171], v26 offset:46080
    ds_read_b64_tr_b16 a[172:173], v27 offset:45056
    s_add_u32 s12, s18, 65536
    s_add_u32 m0, s94, 40960
    s_nop 0
    buffer_load_dwordx4 v18, s[64:67], s12 offen offset:0 lds
    s_waitcnt lgkmcnt(6)
    v_mfma_f32_32x32x16_bf16 v[80:95], a[144:147], a[128:131], v[80:95]
    ds_read_b64_tr_b16 a[174:175], v27 offset:46080
    ds_read_b64_tr_b16 a[176:177], v28 offset:45056
    v_mfma_f32_32x32x16_bf16 v[96:111], a[148:151], a[128:131], v[96:111]
    ds_read_b64_tr_b16 a[178:179], v28 offset:46080
    ds_read_b64_tr_b16 a[180:181], v29 offset:45056
    buffer_load_dwordx4 v19, s[64:67], s12 offen offset:1024 lds
    v_mfma_f32_32x32x16_bf16 v[112:127], a[152:155], a[128:131], v[112:127]
    ds_read_b64_tr_b16 a[182:183], v29 offset:46080
    s_waitcnt lgkmcnt(6)
    v_mfma_f32_32x32x16_bf16 v[128:143], a[156:159], a[160:163], v[128:143]
    ds_read_b128 a[128:131], v24 offset:40960
    ds_read_b128 a[132:135], v32 offset:40960
    buffer_load_dwordx4 v20, s[64:67], s12 offen offset:2048 lds
    v_mfma_f32_32x32x16_bf16 v[144:159], a[156:159], a[164:167], v[144:159]
    ds_read_b128 a[136:139], v32 offset:45056
    ds_read_b64_tr_b16 a[140:141], v26 offset:49152
    v_mfma_f32_32x32x16_bf16 v[64:79], a[168:171], a[156:159], v[64:79]
    ds_read_b64_tr_b16 a[142:143], v26 offset:50176
    ds_read_b64_tr_b16 a[144:145], v27 offset:49152
    buffer_load_dwordx4 v21, s[64:67], s12 offen offset:3072 lds
    s_waitcnt lgkmcnt(6)
    v_mfma_f32_32x32x16_bf16 v[80:95], a[172:175], a[156:159], v[80:95]
    ds_read_b64_tr_b16 a[146:147], v27 offset:50176
    ds_read_b64_tr_b16 a[148:149], v28 offset:49152
    v_mfma_f32_32x32x16_bf16 v[96:111], a[176:179], a[156:159], v[96:111]
    ds_read_b64_tr_b16 a[150:151], v28 offset:50176
    ds_read_b64_tr_b16 a[152:153], v29 offset:49152
    s_add_u32 m0, m0, 4096
    s_xor_b32 s12, s12, 32768
    buffer_load_dwordx4 v18, s[64:67], s12 offen offset:0 lds
    v_mfma_f32_32x32x16_bf16 v[112:127], a[180:183], a[156:159], v[112:127]
    ds_read_b64_tr_b16 a[154:155], v29 offset:50176
    s_waitcnt lgkmcnt(6)
    v_mfma_f32_32x32x16_bf16 v[128:143], a[128:131], a[132:135], v[128:143]
    ds_read_b128 a[156:159], v25 offset:40960
    ds_read_b128 a[160:163], v33 offset:40960
    buffer_load_dwordx4 v19, s[64:67], s12 offen offset:1024 lds
    v_mfma_f32_32x32x16_bf16 v[144:159], a[128:131], a[136:139], v[144:159]
    ds_read_b128 a[164:167], v33 offset:45056
    ds_read_b64_tr_b16 a[168:169], v26 offset:53248
    v_mfma_f32_32x32x16_bf16 v[64:79], a[140:143], a[128:131], v[64:79]
    ds_read_b64_tr_b16 a[170:171], v26 offset:54272
    ds_read_b64_tr_b16 a[172:173], v27 offset:53248
    buffer_load_dwordx4 v20, s[64:67], s12 offen offset:2048 lds
    s_waitcnt lgkmcnt(6)
    v_mfma_f32_32x32x16_bf16 v[80:95], a[144:147], a[128:131], v[80:95]
    ds_read_b64_tr_b16 a[174:175], v27 offset:54272
    ds_read_b64_tr_b16 a[176:177], v28 offset:53248
    v_mfma_f32_32x32x16_bf16 v[96:111], a[148:151], a[128:131], v[96:111]
    ds_read_b64_tr_b16 a[178:179], v28 offset:54272
    ds_read_b64_tr_b16 a[180:181], v29 offset:53248
    buffer_load_dwordx4 v21, s[64:67], s12 offen offset:3072 lds
    v_mfma_f32_32x32x16_bf16 v[112:127], a[152:155], a[128:131], v[112:127]
    ds_read_b64_tr_b16 a[182:183], v29 offset:54272
    s_waitcnt lgkmcnt(6)
    v_mfma_f32_32x32x16_bf16 v[128:143], a[156:159], a[160:163], v[128:143]
    v_mfma_f32_32x32x16_bf16 v[144:159], a[156:159], a[164:167], v[144:159]
    v_mfma_f32_32x32x16_bf16 v[64:79], a[168:171], a[156:159], v[64:79]
    s_waitcnt lgkmcnt(0)
    v_mfma_f32_32x32x16_bf16 v[80:95], a[172:175], a[156:159], v[80:95]
    v_mfma_f32_32x32x16_bf16 v[96:111], a[176:179], a[156:159], v[96:111]
    v_mfma_f32_32x32x16_bf16 v[112:127], a[180:183], a[156:159], v[112:127]
    s_waitcnt vmcnt(8)
    v_xor_b32 v244, s10, v229
    v_xor_b32 v245, s10, v209
    v_or_b32 v244, v244, v245
    v_xor_b32 v245, s10, v201
    v_or_b32 v244, v244, v245
    v_xor_b32 v245, s10, v205
    v_or_b32 v244, v244, v245
    v_cmp_ne_u32 vcc, 0, v244
    s_mov_b32 s90, 0
    s_nop 0
    s_cbranch_vccnz L_gran_again_1
L_gran_ok_2:
    v_and_b32 v244, 0xffff, v228
    v_and_b32 v245, 0xffff0000, v228
    v_lshlrev_b32 v63, 16, v228
    v_rcp_f32 v249, v245
    v_xor_b32 v244, 0x8000, v244
    v_lshrrev_b32 v245, 16, v228
    v_lshl_or_b32 v244, v244, 16, v244
    v_cndmask_b32 v192, v244, 0, s[98:99]
    v_cndmask_b32 v193, v245, 0, s[98:99]
    v_cndmask_b32 v196, 0, v244, s[98:99]
    v_cndmask_b32 v197, 0, v245, s[98:99]
    v_mov_b32 v209, 0
    s_lshr_b32 s3, s93, 5
    s_add_u32 s3, s3, 32768
    v_lshlrev_b32 v244, 9, v3
    v_lshl_add_u32 v244, v5, 2, v244
    v_add_u32 v244, s3, v244
    v_lshlrev_b32 v246, 6, v3
    v_add_u32 v246, s3, v246
    v_mfma_f32_32x32x16_bf16 v[128:143], v[192:195], v[208:211], v[128:143]
    v_mfma_f32_32x32x16_bf16 v[144:159], v[196:199], v[208:211], v[144:159]
    v_cndmask_b32 v245, v249, v63, s[98:99]
    v_mul_f32 v248, 0x3fb8aa3b, v249
    ds_write_b32 v244, v245
    v_mov_b32 v201, v251
    v_mov_b32 v205, v252
    s_lshl_b32 s3, s97, 13
    s_add_u32 s87, s91, s3
    v_mfma_f32_32x32x16_bf16 v[64:79], v[200:203], v[192:195], v[64:79]
    v_mfma_f32_32x32x16_bf16 v[80:95], v[200:203], v[196:199], v[80:95]
    v_mfma_f32_32x32x16_bf16 v[96:111], v[204:207], v[192:195], v[96:111]
    v_mfma_f32_32x32x16_bf16 v[112:127], v[204:207], v[196:199], v[112:127]
    s_barrier
    s_add_u32 s12, s18, 131072
    s_add_u32 m0, s94, 81920
    s_nop 0
    buffer_load_dwordx4 v18, s[64:67], s12 offen offset:0 lds
    ds_read_b64_tr_b16 a[128:129], v42 offset:0
    ds_read_b64_tr_b16 a[130:131], v42 offset:1024
    ds_read_b64_tr_b16 a[132:133], v43 offset:0
    ds_read_b64_tr_b16 a[134:135], v43 offset:1024
    ds_read_b64_tr_b16 a[136:137], v42 offset:2048
    ds_read_b64_tr_b16 a[138:139], v42 offset:3072
    ds_read_b64_tr_b16 a[140:141], v43 offset:2048
    ds_read_b64_tr_b16 a[142:143], v43 offset:3072
    ds_read_b64_tr_b16 a[144:145], v42 offset:4096
    ds_read_b64_tr_b16 a[146:147], v42 offset:5120
    ds_read_b64_tr_b16 a[148:149], v43 offset:4096
    ds_read_b64_tr_b16 a[150:151], v43 offset:5120
    ds_read_b64_tr_b16 a[152:153], v42 offset:6144
    ds_read_b64_tr_b16 a[154:155], v42 offset:7168
    ds_read_b64_tr_b16 a[156:157], v43 offset:6144
    ds_read_b64_tr_b16 a[158:159], v43 offset:7168
    v_pk_mul_f32 v[212:213], v[64:65], v[248:249] op_sel_hi:[1,0]
    v_pk_mul_f32 v[214:215], v[66:67], v[248:249] op_sel_hi:[1,0]
    v_pk_mul_f32 v[216:217], v[68:69], v[248:249] op_sel_hi:[1,0]
    v_pk_mul_f32 v[218:219], v[70:71], v[248:249] op_sel_hi:[1,0]
    v_exp_f32 v220, v212
    v_exp_f32 v221, v213
    v_exp_f32 v222, v214
    v_exp_f32 v223, v215
    v_exp_f32 v224, v216
    buffer_load_dwordx4 v19, s[64:67], s12 offen offset:1024 lds
    v_exp_f32 v225, v217
    v_exp_f32 v226, v218
    v_exp_f32 v227, v219
    v_pk_fma_f32 v[64:65], v[220:221], 0.5, 1.0 op_sel_hi:[1,0,0]
    v_pk_fma_f32 v[66:67], v[222:223], 0.5, 1.0 op_sel_hi:[1,0,0]
    v_pk_fma_f32 v[68:69], v[224:225], 0.5, 1.0 op_sel_hi:[1,0,0]
    v_pk_fma_f32 v[70:71], v[226:227], 0.5, 1.0 op_sel_hi:[1,0,0]
    v_pk_fma_f32 v[220:221], v[220:221], v[64:65], 1.0 op_sel_hi:[1,1,0]
    v_pk_fma_f32 v[222:223], v[222:223], v[66:67], 1.0 op_sel_hi:[1,1,0]
    v_pk_fma_f32 v[224:225], v[224:225], v[68:69], 1.0 op_sel_hi:[1,1,0]
    v_pk_fma_f32 v[226:227], v[226:227], v[70:71], 1.0 op_sel_hi:[1,1,0]
    v_rcp_f32 v220, v220
    v_rcp_f32 v221, v221
    v_rcp_f32 v222, v222
    v_rcp_f32 v223, v223
    v_rcp_f32 v224, v224
    v_rcp_f32 v225, v225
    v_rcp_f32 v226, v226
    buffer_load_dwordx4 v20, s[64:67], s12 offen offset:2048 lds
    v_rcp_f32 v227, v227
    v_pk_fma_f32 v[212:213], v[212:213], v[220:221], v[212:213] neg_lo:[1,0,0] neg_hi:[1,0,0]
    v_pk_fma_f32 v[214:215], v[214:215], v[222:223], v[214:215] neg_lo:[1,0,0] neg_hi:[1,0,0]
    v_pk_fma_f32 v[216:217], v[216:217], v[224:225], v[216:217] neg_lo:[1,0,0] neg_hi:[1,0,0]
    v_pk_fma_f32 v[218:219], v[218:219], v[226:227], v[218:219] neg_lo:[1,0,0] neg_hi:[1,0,0]
    v_cvt_pk_bf16_f32 v64, v212, v213
    v_cvt_pk_bf16_f32 v65, v214, v215
    v_cvt_pk_bf16_f32 v66, v216, v217
    v_cvt_pk_bf16_f32 v67, v218, v219
    buffer_store_dwordx4 v[64:67], v4, s[76:79], s87 offen offset:0 sc1
    v_pk_mul_f32 v[212:213], v[72:73], v[248:249] op_sel_hi:[1,0]
    v_pk_mul_f32 v[214:215], v[74:75], v[248:249] op_sel_hi:[1,0]
    v_pk_mul_f32 v[216:217], v[76:77], v[248:249] op_sel_hi:[1,0]
    v_pk_mul_f32 v[218:219], v[78:79], v[248:249] op_sel_hi:[1,0]
    v_exp_f32 v220, v212
    v_exp_f32 v221, v213
    v_exp_f32 v222, v214
    v_exp_f32 v223, v215
    v_exp_f32 v224, v216
    v_exp_f32 v225, v217
    v_exp_f32 v226, v218
    buffer_load_dwordx4 v21, s[64:67], s12 offen offset:3072 lds
    v_exp_f32 v227, v219
    v_pk_fma_f32 v[72:73], v[220:221], 0.5, 1.0 op_sel_hi:[1,0,0]
    v_pk_fma_f32 v[74:75], v[222:223], 0.5, 1.0 op_sel_hi:[1,0,0]
    v_pk_fma_f32 v[76:77], v[224:225], 0.5, 1.0 op_sel_hi:[1,0,0]
    v_pk_fma_f32 v[78:79], v[226:227], 0.5, 1.0 op_sel_hi:[1,0,0]
    v_pk_fma_f32 v[220:221], v[220:221], v[72:73], 1.0 op_sel_hi:[1,1,0]
    v_pk_fma_f32 v[222:223], v[222:223], v[74:75], 1.0 op_sel_hi:[1,1,0]
    v_pk_fma_f32 v[224:225], v[224:225], v[76:77], 1.0 op_sel_hi:[1,1,0]
    v_pk_fma_f32 v[226:227], v[226:227], v[78:79], 1.0 op_sel_hi:[1,1,0]
    v_rcp_f32 v220, v220
    v_rcp_f32 v221, v221
    v_rcp_f32 v222, v222
    v_rcp_f32 v223, v223
    v_rcp_f32 v224, v224
    v_rcp_f32 v225, v225
    v_rcp_f32 v226, v226
    v_rcp_f32 v227, v227
    v_pk_fma_f32 v[212:213], v[212:213], v[220:221], v[212:213] neg_lo:[1,0,0] neg_hi:[1,0,0]
    s_add_u32 m0, m0, 4096
    s_xor_b32 s12, s12, 32768
    buffer_load_dwordx4 v18, s[64:67], s12 offen offset:0 lds
    v_pk_fma_f32 v[214:215], v[214:215], v[222:223], v[214:215] neg_lo:[1,0,0] neg_hi:[1,0,0]
    v_pk_fma_f32 v[216:217], v[216:217], v[224:225], v[216:217] neg_lo:[1,0,0] neg_hi:[1,0,0]
    v_pk_fma_f32 v[218:219], v[218:219], v[226:227], v[218:219] neg_lo:[1,0,0] neg_hi:[1,0,0]
    v_cvt_pk_bf16_f32 v72, v212, v213
    v_cvt_pk_bf16_f32 v73, v214, v215
    v_cvt_pk_bf16_f32 v74, v216, v217
    v_cvt_pk_bf16_f32 v75, v218, v219
    buffer_store_dwordx4 v[72:75], v4, s[76:79], s87 offen offset:1024 sc1
    s_waitcnt vmcnt(7)
    ds_read_b64_tr_b16 a[160:161], v42 offset:40960
    ds_read_b64_tr_b16 a[162:163], v42 offset:41984
    ds_read_b64_tr_b16 a[164:165], v43 offset:40960
    ds_read_b64_tr_b16 a[166:167], v43 offset:41984
    ds_read_b64_tr_b16 a[168:169], v42 offset:43008
    ds_read_b64_tr_b16 a[170:171], v42 offset:44032
    ds_read_b64_tr_b16 a[172:173], v43 offset:43008
    ds_read_b64_tr_b16 a[174:175], v43 offset:44032
    ds_read_b64_tr_b16 a[176:177], v42 offset:45056
    ds_read_b64_tr_b16 a[178:179], v42 offset:46080
    ds_read_b64_tr_b16 a[180:181], v43 offset:45056
    ds_read_b64_tr_b16 a[182:183], v43 offset:46080
    ds_read_b64_tr_b16 a[184:185], v42 offset:47104
    ds_read_b64_tr_b16 a[186:187], v42 offset:48128
    ds_read_b64_tr_b16 a[188:189], v43 offset:47104
    ds_read_b64_tr_b16 a[190:191], v43 offset:48128
    v_pk_mul_f32 v[212:213], v[80:81], v[248:249] op_sel_hi:[1,0]
    v_pk_mul_f32 v[214:215], v[82:83], v[248:249] op_sel_hi:[1,0]
    v_pk_mul_f32 v[216:217], v[84:85], v[248:249] op_sel_hi:[1,0]
    v_pk_mul_f32 v[218:219], v[86:87], v[248:249] op_sel_hi:[1,0]
    v_exp_f32 v220, v212
    buffer_load_dwordx4 v19, s[64:67], s12 offen offset:1024 lds
    v_exp_f32 v221, v213
    v_exp_f32 v222, v214
    v_exp_f32 v223, v215
    v_exp_f32 v224, v216
    v_exp_f32 v225, v217
    v_exp_f32 v226, v218
    v_exp_f32 v227, v219
    v_pk_fma_f32 v[80:81], v[220:221], 0.5, 1.0 op_sel_hi:[1,0,0]
    v_pk_fma_f32 v[82:83], v[222:223], 0.5, 1.0 op_sel_hi:[1,0,0]
    v_pk_fma_f32 v[84:85], v[224:225], 0.5, 1.0 op_sel_hi:[1,0,0]
    v_pk_fma_f32 v[86:87], v[226:227], 0.5, 1.0 op_sel_hi:[1,0,0]
    v_pk_fma_f32 v[220:221], v[220:221], v[80:81], 1.0 op_sel_hi:[1,1,0]
    v_pk_fma_f32 v[222:223], v[222:223], v[82:83], 1.0 op_sel_hi:[1,1,0]
    v_pk_fma_f32 v[224:225], v[224:225], v[84:85], 1.0 op_sel_hi:[1,1,0]
    v_pk_fma_f32 v[226:227], v[226:227], v[86:87], 1.0 op_sel_hi:[1,1,0]
    v_rcp_f32 v220, v220
    v_rcp_f32 v221, v221
    v_rcp_f32 v222, v222
    buffer_load_dwordx4 v20, s[64:67], s12 offen offset:2048 lds
    v_rcp_f32 v223, v223
    v_rcp_f32 v224, v224
    v_rcp_f32 v225, v225
    v_rcp_f32 v226, v226
    v_rcp_f32 v227, v227
    v_pk_fma_f32 v[212:213], v[212:213], v[220:221], v[212:213] neg_lo:[1,0,0] neg_hi:[1,0,0]
    v_pk_fma_f32 v[214:215], v[214:215], v[222:223], v[214:215] neg_lo:[1,0,0] neg_hi:[1,0,0]
    v_pk_fma_f32 v[216:217], v[216:217], v[224:225], v[216:217] neg_lo:[1,0,0] neg_hi:[1,0,0]
    v_pk_fma_f32 v[218:219], v[218:219], v[226:227], v[218:219] neg_lo:[1,0,0] neg_hi:[1,0,0]
    v_cvt_pk_bf16_f32 v80, v212, v213
    v_cvt_pk_bf16_f32 v81, v214, v215
    v_cvt_pk_bf16_f32 v82, v216, v217
    v_cvt_pk_bf16_f32 v83, v218, v219
    buffer_store_dwordx4 v[80:83], v4, s[76:79], s87 offen offset:2048 sc1
    v_pk_mul_f32 v[212:213], v[88:89], v[248:249] op_sel_hi:[1,0]
    v_pk_mul_f32 v[214:215], v[90:91], v[248:249] op_sel_hi:[1,0]
    v_pk_mul_f32 v[216:217], v[92:93], v[248:249] op_sel_hi:[1,0]
    v_pk_mul_f32 v[218:219], v[94:95], v[248:249] op_sel_hi:[1,0]
    v_exp_f32 v220, v212
    v_exp_f32 v221, v213
    v_exp_f32 v222, v214
    buffer_load_dwordx4 v21, s[64:67], s12 offen offset:3072 lds
    v_exp_f32 v223, v215
    v_exp_f32 v224, v216
    v_exp_f32 v225, v217
    v_exp_f32 v226, v218
    v_exp_f32 v227, v219
    v_pk_fma_f32 v[88:89], v[220:221], 0.5, 1.0 op_sel_hi:[1,0,0]
    v_pk_fma_f32 v[90:91], v[222:223], 0.5, 1.0 op_sel_hi:[1,0,0]
    v_pk_fma_f32 v[92:93], v[224:225], 0.5, 1.0 op_sel_hi:[1,0,0]
    v_pk_fma_f32 v[94:95], v[226:227], 0.5, 1.0 op_sel_hi:[1,0,0]
    v_pk_fma_f32 v[220:221], v[220:221], v[88:89], 1.0 op_sel_hi:[1,1,0]
    v_pk_fma_f32 v[222:223], v[222:223], v[90:91], 1.0 op_sel_hi:[1,1,0]
    v_pk_fma_f32 v[224:225], v[224:225], v[92:93], 1.0 op_sel_hi:[1,1,0]
    v_pk_fma_f32 v[226:227], v[226:227], v[94:95], 1.0 op_sel_hi:[1,1,0]
    v_rcp_f32 v220, v220
    v_rcp_f32 v221, v221
    v_rcp_f32 v222, v222
    v_rcp_f32 v223, v223
    v_rcp_f32 v224, v224
    s_add_u32 s12, s18, 196608
    s_add_u32 m0, s94, 122880
    s_nop 0
    buffer_load_dwordx4 v18, s[64:67], s12 offen offset:0 lds
    v_rcp_f32 v225, v225
    v_rcp_f32 v226, v226
    v_rcp_f32 v227, v227
    v_pk_fma_f32 v[212:213], v[212:213], v[220:221], v[212:213] neg_lo:[1,0,0] neg_hi:[1,0,0]
    v_pk_fma_f32 v[214:215], v[214:215], v[222:223], v[214:215] neg_lo:[1,0,0] neg_hi:[1,0,0]
    v_pk_fma_f32 v[216:217], v[216:217], v[224:225], v[216:217] neg_lo:[1,0,0] neg_hi:[1,0,0]
    v_pk_fma_f32 v[218:219], v[218:219], v[226:227], v[218:219] neg_lo:[1,0,0] neg_hi:[1,0,0]
    v_cvt_pk_bf16_f32 v88, v212, v213
    v_cvt_pk_bf16_f32 v89, v214, v215
    v_cvt_pk_bf16_f32 v90, v216, v217
    v_cvt_pk_bf16_f32 v91, v218, v219
    buffer_store_dwordx4 v[88:91], v4, s[76:79], s87 offen offset:3072 sc1
    v_pk_mul_f32 v[212:213], v[96:97], v[248:249] op_sel_hi:[1,0]
    v_pk_mul_f32 v[214:215], v[98:99], v[248:249] op_sel_hi:[1,0]
    v_pk_mul_f32 v[216:217], v[100:101], v[248:249] op_sel_hi:[1,0]
    v_pk_mul_f32 v[218:219], v[102:103], v[248:249] op_sel_hi:[1,0]
    v_exp_f32 v220, v212
    v_exp_f32 v221, v213
    v_exp_f32 v222, v214
    v_exp_f32 v223, v215
    v_exp_f32 v224, v216
    buffer_load_dwordx4 v19, s[64:67], s12 offen offset:1024 lds
    v_exp_f32 v225, v217
    v_exp_f32 v226, v218
    v_exp_f32 v227, v219
    v_pk_fma_f32 v[96:97], v[220:221], 0.5, 1.0 op_sel_hi:[1,0,0]
    v_pk_fma_f32 v[98:99], v[222:223], 0.5, 1.0 op_sel_hi:[1,0,0]
    v_pk_fma_f32 v[100:101], v[224:225], 0.5, 1.0 op_sel_hi:[1,0,0]
    v_pk_fma_f32 v[102:103], v[226:227], 0.5, 1.0 op_sel_hi:[1,0,0]
    v_pk_fma_f32 v[220:221], v[220:221], v[96:97], 1.0 op_sel_hi:[1,1,0]
    v_pk_fma_f32 v[222:223], v[222:223], v[98:99], 1.0 op_sel_hi:[1,1,0]
    v_pk_fma_f32 v[224:225], v[224:225], v[100:101], 1.0 op_sel_hi:[1,1,0]
    v_pk_fma_f32 v[226:227], v[226:227], v[102:103], 1.0 op_sel_hi:[1,1,0]
    v_rcp_f32 v220, v220
    v_rcp_f32 v221, v221
    v_rcp_f32 v222, v222
    v_rcp_f32 v223, v223
    v_rcp_f32 v224, v224
    v_rcp_f32 v225, v225
    v_rcp_f32 v226, v226
    buffer_load_dwordx4 v20, s[64:67], s12 offen offset:2048 lds
    v_rcp_f32 v227, v227
    v_pk_fma_f32 v[212:213], v[212:213], v[220:221], v[212:213] neg_lo:[1,0,0] neg_hi:[1,0,0]
    v_pk_fma_f32 v[214:215], v[214:215], v[222:223], v[214:215] neg_lo:[1,0,0] neg_hi:[1,0,0]
    v_pk_fma_f32 v[216:217], v[216:217], v[224:225], v[216:217] neg_lo:[1,0,0] neg_hi:[1,0,0]
    v_pk_fma_f32 v[218:219], v[218:219], v[226:227], v[218:219] neg_lo:[1,0,0] neg_hi:[1,0,0]
    v_cvt_pk_bf16_f32 v96, v212, v213
    v_cvt_pk_bf16_f32 v97, v214, v215
    v_cvt_pk_bf16_f32 v98, v216, v217
    v_cvt_pk_bf16_f32 v99, v218, v219
    s_add_u32 s87, s87, 4096
    buffer_store_dwordx4 v[96:99], v4, s[76:79], s87 offen offset:0 sc1
    v_pk_mul_f32 v[212:213], v[104:105], v[248:249] op_sel_hi:[1,0]
    v_pk_mul_f32 v[214:215], v[106:107], v[248:249] op_sel_hi:[1,0]
    v_pk_mul_f32 v[216:217], v[108:109], v[248:249] op_sel_hi:[1,0]
    v_pk_mul_f32 v[218:219], v[110:111], v[248:249] op_sel_hi:[1,0]
    v_exp_f32 v220, v212
    v_exp_f32 v221, v213
    v_exp_f32 v222, v214
    v_exp_f32 v223, v215
    v_exp_f32 v224, v216
    v_exp_f32 v225, v217
    v_exp_f32 v226, v218
    buffer_load_dwordx4 v21, s[64:67], s12 offen offset:3072 lds
    v_exp_f32 v227, v219
    v_pk_fma_f32 v[104:105], v[220:221], 0.5, 1.0 op_sel_hi:[1,0,0]
    v_pk_fma_f32 v[106:107], v[222:223], 0.5, 1.0 op_sel_hi:[1,0,0]
    v_pk_fma_f32 v[108:109], v[224:225], 0.5, 1.0 op_sel_hi:[1,0,0]
    v_pk_fma_f32 v[110:111], v[226:227], 0.5, 1.0 op_sel_hi:[1,0,0]
    v_pk_fma_f32 v[220:221], v[220:221], v[104:105], 1.0 op_sel_hi:[1,1,0]
    v_pk_fma_f32 v[222:223], v[222:223], v[106:107], 1.0 op_sel_hi:[1,1,0]
    v_pk_fma_f32 v[224:225], v[224:225], v[108:109], 1.0 op_sel_hi:[1,1,0]
    v_pk_fma_f32 v[226:227], v[226:227], v[110:111], 1.0 op_sel_hi:[1,1,0]
    v_rcp_f32 v220, v220
    v_rcp_f32 v221, v221
    v_rcp_f32 v222, v222
    v_rcp_f32 v223, v223
    v_rcp_f32 v224, v224
    v_rcp_f32 v225, v225
    v_rcp_f32 v226, v226
    v_rcp_f32 v227, v227
    v_pk_fma_f32 v[212:213], v[212:213], v[220:221], v[212:213] neg_lo:[1,0,0] neg_hi:[1,0,0]
    s_add_u32 m0, m0, 4096
    s_xor_b32 s12, s12, 32768
    buffer_load_dwordx4 v18, s[64:67], s12 offen offset:0 lds
    v_pk_fma_f32 v[214:215], v[214:215], v[222:223], v[214:215] neg_lo:[1,0,0] neg_hi:[1,0,0]
    v_pk_fma_f32 v[216:217], v[216:217], v[224:225], v[216:217] neg_lo:[1,0,0] neg_hi:[1,0,0]
    v_pk_fma_f32 v[218:219], v[218:219], v[226:227], v[218:219] neg_lo:[1,0,0] neg_hi:[1,0,0]
    v_cvt_pk_bf16_f32 v104, v212, v213
    v_cvt_pk_bf16_f32 v105, v214, v215
    v_cvt_pk_bf16_f32 v106, v216, v217
    v_cvt_pk_bf16_f32 v107, v218, v219
    buffer_store_dwordx4 v[104:107], v4, s[76:79], s87 offen offset:1024 sc1
    v_pk_mul_f32 v[212:213], v[112:113], v[248:249] op_sel_hi:[1,0]
    v_pk_mul_f32 v[214:215], v[114:115], v[248:249] op_sel_hi:[1,0]
    v_pk_mul_f32 v[216:217], v[116:117], v[248:249] op_sel_hi:[1,0]
    v_pk_mul_f32 v[218:219], v[118:119], v[248:249] op_sel_hi:[1,0]
    v_exp_f32 v220, v212
    v_exp_f32 v221, v213
    v_exp_f32 v222, v214
    v_exp_f32 v223, v215
    v_exp_f32 v224, v216
    v_exp_f32 v225, v217
    v_exp_f32 v226, v218
    v_exp_f32 v227, v219
    v_pk_fma_f32 v[112:113], v[220:221], 0.5, 1.0 op_sel_hi:[1,0,0]
    buffer_load_dwordx4 v19, s[64:67], s12 offen offset:1024 lds
    v_pk_fma_f32 v[114:115], v[222:223], 0.5, 1.0 op_sel_hi:[1,0,0]
    v_pk_fma_f32 v[116:117], v[224:225], 0.5, 1.0 op_sel_hi:[1,0,0]
    v_pk_fma_f32 v[118:119], v[226:227], 0.5, 1.0 op_sel_hi:[1,0,0]
    v_pk_fma_f32 v[220:221], v[220:221], v[112:113], 1.0 op_sel_hi:[1,1,0]
    v_pk_fma_f32 v[222:223], v[222:223], v[114:115], 1.0 op_sel_hi:[1,1,0]
    v_pk_fma_f32 v[224:225], v[224:225], v[116:117], 1.0 op_sel_hi:[1,1,0]
    v_pk_fma_f32 v[226:227], v[226:227], v[118:119], 1.0 op_sel_hi:[1,1,0]
    v_rcp_f32 v220, v220
    v_rcp_f32 v221, v221
    v_rcp_f32 v222, v222
    v_rcp_f32 v223, v223
    v_rcp_f32 v224, v224
    v_rcp_f32 v225, v225
    v_rcp_f32 v226, v226
    v_rcp_f32 v227, v227
    v_pk_fma_f32 v[212:213], v[212:213], v[220:221], v[212:213] neg_lo:[1,0,0] neg_hi:[1,0,0]
    v_pk_fma_f32 v[214:215], v[214:215], v[222:223], v[214:215] neg_lo:[1,0,0] neg_hi:[1,0,0]
    v_pk_fma_f32 v[216:217], v[216:217], v[224:225], v[216:217] neg_lo:[1,0,0] neg_hi:[1,0,0]
    v_pk_fma_f32 v[218:219], v[218:219], v[226:227], v[218:219] neg_lo:[1,0,0] neg_hi:[1,0,0]
    v_cvt_pk_bf16_f32 v112, v212, v213
    buffer_load_dwordx4 v20, s[64:67], s12 offen offset:2048 lds
    v_cvt_pk_bf16_f32 v113, v214, v215
    v_cvt_pk_bf16_f32 v114, v216, v217
    v_cvt_pk_bf16_f32 v115, v218, v219
    buffer_store_dwordx4 v[112:115], v4, s[76:79], s87 offen offset:2048 sc1
    v_pk_mul_f32 v[212:213], v[120:121], v[248:249] op_sel_hi:[1,0]
    v_pk_mul_f32 v[214:215], v[122:123], v[248:249] op_sel_hi:[1,0]
    v_pk_mul_f32 v[216:217], v[124:125], v[248:249] op_sel_hi:[1,0]
    v_pk_mul_f32 v[218:219], v[126:127], v[248:249] op_sel_hi:[1,0]
    v_exp_f32 v220, v212
    v_exp_f32 v221, v213
    v_exp_f32 v222, v214
    v_exp_f32 v223, v215
    v_exp_f32 v224, v216
    v_exp_f32 v225, v217
    v_exp_f32 v226, v218
    v_exp_f32 v227, v219
    v_pk_fma_f32 v[120:121], v[220:221], 0.5, 1.0 op_sel_hi:[1,0,0]
    v_pk_fma_f32 v[122:123], v[222:223], 0.5, 1.0 op_sel_hi:[1,0,0]
    v_pk_fma_f32 v[124:125], v[224:225], 0.5, 1.0 op_sel_hi:[1,0,0]
    v_pk_fma_f32 v[126:127], v[226:227], 0.5, 1.0 op_sel_hi:[1,0,0]
    v_pk_fma_f32 v[220:221], v[220:221], v[120:121], 1.0 op_sel_hi:[1,1,0]
    buffer_load_dwordx4 v21, s[64:67], s12 offen offset:3072 lds
    v_pk_fma_f32 v[222:223], v[222:223], v[122:123], 1.0 op_sel_hi:[1,1,0]
    v_pk_fma_f32 v[224:225], v[224:225], v[124:125], 1.0 op_sel_hi:[1,1,0]
    v_pk_fma_f32 v[226:227], v[226:227], v[126:127], 1.0 op_sel_hi:[1,1,0]
    v_rcp_f32 v220, v220
    v_rcp_f32 v221, v221
    v_rcp_f32 v222, v222
    v_rcp_f32 v223, v223
    v_rcp_f32 v224, v224
    v_rcp_f32 v225, v225
    v_rcp_f32 v226, v226
    v_rcp_f32 v227, v227
    v_pk_fma_f32 v[212:213], v[212:213], v[220:221], v[212:213] neg_lo:[1,0,0] neg_hi:[1,0,0]
    v_pk_fma_f32 v[214:215], v[214:215], v[222:223], v[214:215] neg_lo:[1,0,0] neg_hi:[1,0,0]
    v_pk_fma_f32 v[216:217], v[216:217], v[224:225], v[216:217] neg_lo:[1,0,0] neg_hi:[1,0,0]
    v_pk_fma_f32 v[218:219], v[218:219], v[226:227], v[218:219] neg_lo:[1,0,0] neg_hi:[1,0,0]
    v_cvt_pk_bf16_f32 v120, v212, v213
    v_cvt_pk_bf16_f32 v121, v214, v215
    v_cvt_pk_bf16_f32 v122, v216, v217
    v_cvt_pk_bf16_f32 v123, v218, v219
    buffer_store_dwordx4 v[120:123], v4, s[76:79], s87 offen offset:3072 sc1
    ds_read_b128 v[212:215], v246 offset:0
    ds_read_b128 v[216:219], v246 offset:16
    ds_read_b128 v[220:223], v246 offset:32
    ds_read_b128 v[224:227], v246 offset:48
    s_add_u32 s12, s18, 262144
    s_add_u32 m0, s94, 0
    s_nop 0
    buffer_load_dwordx4 v18, s[64:67], s12 offen offset:0 lds
    s_waitcnt lgkmcnt(0)
    v_pk_mul_f32 v[128:129], v[128:129], v[212:213]
    v_pk_mul_f32 v[144:145], v[144:145], v[212:213]
    v_pk_mul_f32 v[130:131], v[130:131], v[214:215]
    v_pk_mul_f32 v[146:147], v[146:147], v[214:215]
    v_pk_mul_f32 v[132:133], v[132:133], v[216:217]
    v_pk_mul_f32 v[148:149], v[148:149], v[216:217]
    v_pk_mul_f32 v[134:135], v[134:135], v[218:219]
    v_pk_mul_f32 v[150:151], v[150:151], v[218:219]
    v_pk_mul_f32 v[136:137], v[136:137], v[220:221]
    v_pk_mul_f32 v[152:153], v[152:153], v[220:221]
    v_pk_mul_f32 v[138:139], v[138:139], v[222:223]
    v_pk_mul_f32 v[154:155], v[154:155], v[222:223]
    v_pk_mul_f32 v[140:141], v[140:141], v[224:225]
    v_pk_mul_f32 v[156:157], v[156:157], v[224:225]
    v_pk_mul_f32 v[142:143], v[142:143], v[226:227]
    v_pk_mul_f32 v[158:159], v[158:159], v[226:227]
    buffer_load_dwordx4 v19, s[64:67], s12 offen offset:1024 lds
    v_fmac_f32 v129, v46, v128
    v_fmac_f32 v145, v46, v144
    v_fmac_f32 v129, v48, v144
    v_fmac_f32 v145, v47, v128
    v_fmac_f32 v130, v46, v129
    v_fmac_f32 v146, v46, v145
    v_fmac_f32 v130, v48, v145
    v_fmac_f32 v146, v47, v129
    v_fmac_f32 v131, v46, v130
    v_fmac_f32 v147, v46, v146
    v_fmac_f32 v131, v48, v146
    v_fmac_f32 v147, v47, v130
    v_fmac_f32 v132, v46, v131
    v_fmac_f32 v148, v46, v147
    v_fmac_f32 v132, v48, v147
    buffer_load_dwordx4 v20, s[64:67], s12 offen offset:2048 lds
    v_fmac_f32 v148, v47, v131
    v_fmac_f32 v133, v46, v132
    v_fmac_f32 v149, v46, v148
    v_fmac_f32 v133, v48, v148
    v_fmac_f32 v149, v47, v132
    v_fmac_f32 v134, v46, v133
    v_fmac_f32 v150, v46, v149
    v_fmac_f32 v134, v48, v149
    v_fmac_f32 v150, v47, v133
    v_fmac_f32 v135, v46, v134
    v_fmac_f32 v151, v46, v150
    v_fmac_f32 v135, v48, v150
    v_fmac_f32 v151, v47, v134
    v_fmac_f32 v136, v46, v135
    v_fmac_f32 v152, v46, v151
    v_fmac_f32 v136, v48, v151
    buffer_load_dwordx4 v21, s[64:67], s12 offen offset:3072 lds
    v_fmac_f32 v152, v47, v135
    v_fmac_f32 v137, v46, v136
    v_fmac_f32 v153, v46, v152
    v_fmac_f32 v137, v48, v152
    v_fmac_f32 v153, v47, v136
    v_fmac_f32 v138, v46, v137
    v_fmac_f32 v154, v46, v153
    v_fmac_f32 v138, v48, v153
    v_fmac_f32 v154, v47, v137
    v_fmac_f32 v139, v46, v138
    v_fmac_f32 v155, v46, v154
    v_fmac_f32 v139, v48, v154
    v_fmac_f32 v155, v47, v138
    v_fmac_f32 v140, v46, v139
    v_fmac_f32 v156, v46, v155
    s_add_u32 m0, m0, 4096
    s_xor_b32 s12, s12, 32768
    buffer_load_dwordx4 v18, s[64:67], s12 offen offset:0 lds
    v_fmac_f32 v140, v48, v155
    v_fmac_f32 v156, v47, v139
    v_fmac_f32 v141, v46, v140
    v_fmac_f32 v157, v46, v156
    v_fmac_f32 v141, v48, v156
    v_fmac_f32 v157, v47, v140
    v_fmac_f32 v142, v46, v141
    v_fmac_f32 v158, v46, v157
    v_fmac_f32 v142, v48, v157
    v_fmac_f32 v158, v47, v141
    v_fmac_f32 v143, v46, v142
    v_fmac_f32 v159, v46, v158
    v_fmac_f32 v143, v48, v158
    v_fmac_f32 v159, v47, v142
    ds_write2_b32 v16, v143, v159 offset0:0 offset1:1
    s_waitcnt lgkmcnt(0)
    s_barrier
    buffer_load_dwordx4 v19, s[64:67], s12 offen offset:1024 lds
    ds_read_b64 v[228:229], v17 offset:0
    ds_read_b64 v[230:231], v17 offset:256
    ds_read_b64 v[232:233], v17 offset:512
    ds_read_b64 v[234:235], v17 offset:768
    ds_read_b64 v[236:237], v17 offset:1024
    ds_read_b64 v[238:239], v17 offset:1280
    ds_read_b64 v[240:241], v17 offset:1536
    ds_read_b64 v[242:243], v17 offset:1792
    s_lshl_b32 s3, s6, 1
    v_add_u32 v245, s3, v3
    v_mov_b32 v61, 0
    v_mov_b32 v62, 0
    buffer_load_dwordx4 v20, s[64:67], s12 offen offset:2048 lds
    v_mov_b32 v193, s10
    v_mov_b32 v195, s10
    s_waitcnt lgkmcnt(4)
    v_cmp_eq_u32 vcc, 1, v245
    v_fmac_f32 v230, v49, v228
    v_fmac_f32 v231, v49, v229
    v_cndmask_b32 v61, v61, v228, vcc
    v_cndmask_b32 v62, v62, v229, vcc
    v_fma_f32 v230, v51, v229, v230
    v_fma_f32 v231, v50, v228, v231
    v_cmp_eq_u32 vcc, 2, v245
    buffer_load_dwordx4 v21, s[64:67], s12 offen offset:3072 lds
    v_fmac_f32 v232, v49, v230
    v_fmac_f32 v233, v49, v231
    v_cndmask_b32 v61, v61, v230, vcc
    v_cndmask_b32 v62, v62, v231, vcc
    v_fma_f32 v232, v51, v231, v232
    v_fma_f32 v233, v50, v230, v233
    v_cmp_eq_u32 vcc, 3, v245
    v_fmac_f32 v234, v49, v232
    v_fmac_f32 v235, v49, v233
    v_cndmask_b32 v61, v61, v232, vcc
    s_add_u32 s12, s18, 327680
    s_add_u32 m0, s94, 40960
    s_nop 0
    buffer_load_dwordx4 v18, s[64:67], s12 offen offset:0 lds
    v_cndmask_b32 v62, v62, v233, vcc
    v_fma_f32 v234, v51, v233, v234
    v_fma_f32 v235, v50, v232, v235
    s_waitcnt lgkmcnt(0)
    v_cmp_eq_u32 vcc, 4, v245
    v_fmac_f32 v236, v49, v234
    v_fmac_f32 v237, v49, v235
    v_cndmask_b32 v61, v61, v234, vcc
    s_lshl_b32 s92, s4, 4
    s_add_u32 s92, s92, s97
    s_lshl_b32 s92, s92, 2
    s_add_u32 s92, s92, s6
    s_lshl_b32 s92, s92, 7
    s_add_u32 s92, s92, 655360
    v_mov_b32 v63, s10
    s_waitcnt vmcnt(9)
    s_mov_b64 exec, 1
    buffer_store_dword v63, off, s[76:79], s92 sc1
    s_mov_b64 exec, -1
    v_cndmask_b32 v62, v62, v235, vcc
    v_fma_f32 v236, v51, v235, v236
    v_fma_f32 v237, v50, v234, v237
    v_cmp_eq_u32 vcc, 5, v245
    buffer_load_dwordx4 v19, s[64:67], s12 offen offset:1024 lds
    v_fmac_f32 v238, v49, v236
    v_fmac_f32 v239, v49, v237
    v_cndmask_b32 v61, v61, v236, vcc
    v_cndmask_b32 v62, v62, v237, vcc
    v_fma_f32 v238, v51, v237, v238
    v_fma_f32 v239, v50, v236, v239
    v_cmp_eq_u32 vcc, 6, v245
    v_fmac_f32 v240, v49, v238
    v_fmac_f32 v241, v49, v239
    v_cndmask_b32 v61, v61, v238, vcc
    buffer_load_dwordx4 v20, s[64:67], s12 offen offset:2048 lds
    v_cndmask_b32 v62, v62, v239, vcc
    v_fma_f32 v240, v51, v239, v240
    v_fma_f32 v241, v50, v238, v241
    v_cmp_eq_u32 vcc, 7, v245
    v_fmac_f32 v242, v49, v240
    v_fmac_f32 v243, v49, v241
    v_cndmask_b32 v61, v61, v240, vcc
    v_cndmask_b32 v62, v62, v241, vcc
    v_fma_f32 v192, v51, v241, v242
    v_fma_f32 v194, v50, v240, v243
    s_cmp_eq_u32 s6, 3
    s_cselect_b32 s3, 0, 0x10000
    v_lshlrev_b32 v245, 13, v3
    v_add3_u32 v245, v245, v4, s3
    s_lshl_b32 s3, s4, 9
    buffer_store_dwordx4 v[192:195], v245, s[60:63], s3 offen sc1
    buffer_load_dwordx4 v21, s[64:67], s12 offen offset:3072 lds
    v_pk_mul_f32 v[196:197], v[128:129], v[60:61] op_sel_hi:[1,0]
    v_pk_mul_f32 v[128:129], v[128:129], v[58:59] op_sel_hi:[1,0]
    v_pk_fma_f32 v[128:129], v[144:145], v[60:61], v[128:129] op_sel_hi:[1,0,1]
    v_pk_fma_f32 v[144:145], v[144:145], v[58:59], v[196:197] op_sel:[0,1,0] op_sel_hi:[1,1,1]
    v_pk_mul_f32 v[198:199], v[130:131], v[60:61] op_sel_hi:[1,0]
    v_pk_mul_f32 v[130:131], v[130:131], v[58:59] op_sel_hi:[1,0]
    v_pk_fma_f32 v[130:131], v[146:147], v[60:61], v[130:131] op_sel_hi:[1,0,1]
    s_add_u32 m0, m0, 4096
    s_xor_b32 s12, s12, 32768
    buffer_load_dwordx4 v18, s[64:67], s12 offen offset:0 lds
    v_pk_fma_f32 v[146:147], v[146:147], v[58:59], v[198:199] op_sel:[0,1,0] op_sel_hi:[1,1,1]
    v_pk_mul_f32 v[196:197], v[132:133], v[60:61] op_sel_hi:[1,0]
    v_pk_mul_f32 v[132:133], v[132:133], v[58:59] op_sel_hi:[1,0]
    v_pk_fma_f32 v[132:133], v[148:149], v[60:61], v[132:133] op_sel_hi:[1,0,1]
    v_pk_fma_f32 v[148:149], v[148:149], v[58:59], v[196:197] op_sel:[0,1,0] op_sel_hi:[1,1,1]
    v_pk_mul_f32 v[198:199], v[134:135], v[60:61] op_sel_hi:[1,0]
    v_pk_mul_f32 v[134:135], v[134:135], v[58:59] op_sel_hi:[1,0]
    v_pk_fma_f32 v[134:135], v[150:151], v[60:61], v[134:135] op_sel_hi:[1,0,1]
    v_pk_fma_f32 v[150:151], v[150:151], v[58:59], v[198:199] op_sel:[0,1,0] op_sel_hi:[1,1,1]
    v_pk_mul_f32 v[196:197], v[136:137], v[60:61] op_sel_hi:[1,0]
    buffer_load_dwordx4 v19, s[64:67], s12 offen offset:1024 lds
    v_pk_mul_f32 v[136:137], v[136:137], v[58:59] op_sel_hi:[1,0]
    v_pk_fma_f32 v[136:137], v[152:153], v[60:61], v[136:137] op_sel_hi:[1,0,1]
    v_pk_fma_f32 v[152:153], v[152:153], v[58:59], v[196:197] op_sel:[0,1,0] op_sel_hi:[1,1,1]
    v_pk_mul_f32 v[198:199], v[138:139], v[60:61] op_sel_hi:[1,0]
    v_pk_mul_f32 v[138:139], v[138:139], v[58:59] op_sel_hi:[1,0]
    v_pk_fma_f32 v[138:139], v[154:155], v[60:61], v[138:139] op_sel_hi:[1,0,1]
    v_pk_fma_f32 v[154:155], v[154:155], v[58:59], v[198:199] op_sel:[0,1,0] op_sel_hi:[1,1,1]
    v_pk_mul_f32 v[196:197], v[140:141], v[60:61] op_sel_hi:[1,0]
    v_pk_mul_f32 v[140:141], v[140:141], v[58:59] op_sel_hi:[1,0]
    v_pk_fma_f32 v[140:141], v[156:157], v[60:61], v[140:141] op_sel_hi:[1,0,1]
    v_pk_fma_f32 v[156:157], v[156:157], v[58:59], v[196:197] op_sel:[0,1,0] op_sel_hi:[1,1,1]
    buffer_load_dwordx4 v20, s[64:67], s12 offen offset:2048 lds
    v_pk_mul_f32 v[198:199], v[142:143], v[60:61] op_sel_hi:[1,0]
    v_pk_mul_f32 v[142:143], v[142:143], v[58:59] op_sel_hi:[1,0]
    v_pk_fma_f32 v[142:143], v[158:159], v[60:61], v[142:143] op_sel_hi:[1,0,1]
    v_pk_fma_f32 v[158:159], v[158:159], v[58:59], v[198:199] op_sel:[0,1,0] op_sel_hi:[1,1,1]
    ds_read_b64_tr_b16 a[192:193], v44 offset:0
    ds_read_b64_tr_b16 a[194:195], v44 offset:1024
    ds_read_b64_tr_b16 a[196:197], v45 offset:0
    ds_read_b64_tr_b16 a[198:199], v45 offset:1024
    ds_read_b64_tr_b16 a[200:201], v44 offset:2048
    ds_read_b64_tr_b16 a[202:203], v44 offset:3072
    buffer_load_dwordx4 v21, s[64:67], s12 offen offset:3072 lds
    ds_read_b64_tr_b16 a[204:205], v45 offset:2048
    ds_read_b64_tr_b16 a[206:207], v45 offset:3072
    ds_read_b64_tr_b16 a[208:209], v44 offset:4096
    ds_read_b64_tr_b16 a[210:211], v44 offset:5120
    ds_read_b64_tr_b16 a[212:213], v45 offset:4096
    ds_read_b64_tr_b16 a[214:215], v45 offset:5120
    ds_read_b64_tr_b16 a[216:217], v44 offset:6144
    ds_read_b64_tr_b16 a[218:219], v44 offset:7168
    ds_read_b64_tr_b16 a[220:221], v45 offset:6144
    ds_read_b64_tr_b16 a[222:223], v45 offset:7168
    s_waitcnt lgkmcnt(0)
    s_add_u32 s12, s18, 393216
    s_add_u32 m0, s94, 81920
    s_nop 0
    buffer_load_dwordx4 v18, s[64:67], s12 offen offset:0 lds
    ds_read_b64_tr_b16 a[224:225], v44 offset:40960
    ds_read_b64_tr_b16 a[226:227], v44 offset:41984
    buffer_load_dwordx4 v19, s[64:67], s12 offen offset:1024 lds
    ds_read_b64_tr_b16 a[228:229], v45 offset:40960
    ds_read_b64_tr_b16 a[230:231], v45 offset:41984
    buffer_load_dwordx4 v20, s[64:67], s12 offen offset:2048 lds
    ds_read_b64_tr_b16 a[232:233], v44 offset:43008
    ds_read_b64_tr_b16 a[234:235], v44 offset:44032
    buffer_load_dwordx4 v21, s[64:67], s12 offen offset:3072 lds
    ds_read_b64_tr_b16 a[236:237], v45 offset:43008
    ds_read_b64_tr_b16 a[238:239], v45 offset:44032
    s_add_u32 m0, m0, 4096
    s_xor_b32 s12, s12, 32768
    buffer_load_dwordx4 v18, s[64:67], s12 offen offset:0 lds
    ds_read_b64_tr_b16 a[240:241], v44 offset:45056
    ds_read_b64_tr_b16 a[242:243], v44 offset:46080
    ds_read_b64_tr_b16 a[244:245], v45 offset:45056
    buffer_load_dwordx4 v19, s[64:67], s12 offen offset:1024 lds
    ds_read_b64_tr_b16 a[246:247], v45 offset:46080
    ds_read_b64_tr_b16 a[248:249], v44 offset:47104
    buffer_load_dwordx4 v20, s[64:67], s12 offen offset:2048 lds
    ds_read_b64_tr_b16 a[250:251], v44 offset:48128
    ds_read_b64_tr_b16 a[252:253], v45 offset:47104
    buffer_load_dwordx4 v21, s[64:67], s12 offen offset:3072 lds
    ds_read_b64_tr_b16 a[254:255], v45 offset:48128
    s_waitcnt lgkmcnt(0)
    s_lshl_b32 s12, s9, 1
    s_and_b32 s3, s6, 1
    s_or_b32 s12, s12, s3
    s_lshl_b32 s12, s12, 15
    s_lshl_b32 s3, s6, 8
    s_add_u32 s12, s12, s3
    s_add_u32 m0, s94, 122880
    s_nop 0
    buffer_load_dwordx4 v10, s[68:71], s12 offen offset:0 lds
    s_waitcnt vmcnt(19)
    ds_read_b64_tr_b16 a[96:97], v42 offset:0
    ds_read_b64_tr_b16 a[98:99], v42 offset:1024
    buffer_load_dwordx4 v11, s[68:71], s12 offen offset:1024 lds
    ds_read_b64_tr_b16 a[100:101], v43 offset:0
    ds_read_b64_tr_b16 a[102:103], v43 offset:1024
    buffer_load_dwordx4 v12, s[68:71], s12 offen offset:2048 lds
    ds_read_b64_tr_b16 a[104:105], v42 offset:2048
    ds_read_b64_tr_b16 a[106:107], v42 offset:3072
    buffer_load_dwordx4 v13, s[68:71], s12 offen offset:3072 lds
    ds_read_b64_tr_b16 a[108:109], v43 offset:2048
    ds_read_b64_tr_b16 a[110:111], v43 offset:3072
    s_add_u32 m0, m0, 4096
    s_xor_b32 s12, s12, 32768
    buffer_load_dwordx4 v10, s[68:71], s12 offen offset:0 lds
    ds_read_b64_tr_b16 a[112:113], v42 offset:4096
    ds_read_b64_tr_b16 a[114:115], v42 offset:5120
    ds_read_b64_tr_b16 a[116:117], v43 offset:4096
    buffer_load_dwordx4 v11, s[68:71], s12 offen offset:1024 lds
    ds_read_b64_tr_b16 a[118:119], v43 offset:5120
    ds_read_b64_tr_b16 a[120:121], v42 offset:6144
    buffer_load_dwordx4 v12, s[68:71], s12 offen offset:2048 lds
    ds_read_b64_tr_b16 a[122:123], v42 offset:7168
    ds_read_b64_tr_b16 a[124:125], v43 offset:6144
    buffer_load_dwordx4 v13, s[68:71], s12 offen offset:3072 lds
    ds_read_b64_tr_b16 a[126:127], v43 offset:7168
    s_waitcnt lgkmcnt(0)
    s_waitcnt lgkmcnt(0)
    s_branch L_join
L_light:
    s_lshl_b32 s92, s4, 1
    s_lshr_b32 s3, s5, 3
    s_add_u32 s92, s92, s3
    s_xor_b32 s3, s7, 0
    s_mul_i32 s89, s3, 229376
    s_lshl_b32 s3, s3, 7
    s_add_u32 s13, s3, s85
    s_add_u32 s12, s3, s84
    s_add_u32 s89, s89, s86
    s_add_u32 m0, s93, 0
    s_nop 0
    buffer_load_dwordx4 v6, s[48:51], s12 offen offset:0 lds
    buffer_load_dwordx4 v7, s[48:51], s12 offen offset:1024 lds
    buffer_load_dwordx4 v8, s[48:51], s12 offen offset:2048 lds
    buffer_load_dwordx4 v9, s[48:51], s12 offen offset:3072 lds
    s_lshr_b32 s3, s93, 1
    s_add_u32 m0, s3, 32768
    s_nop 0
    buffer_load_dwordx4 v10, s[56:59], s13 offen offset:0 lds
    buffer_load_dwordx4 v11, s[56:59], s13 offen offset:1024 lds
    global_load_ushort v212, v229, s[18:19]
    global_load_ushort v213, v229, s[20:21]
    global_load_ushort v214, v229, s[30:31]
    global_load_ushort v251, v230, s[38:39]
    global_load_ushort v252, v230, s[38:39] offset:128
    global_load_ushort v250, v231, s[32:33]
    s_cmp_lt_u32 s92, 16
    s_cselect_b32 s36, s22, s24
    s_cselect_b32 s37, s23, s25
    s_mov_b32 s38, 0x80000
    s_mov_b32 s39, 0x20000
    s_xor_b32 s3, s7, 1
    s_mul_i32 s89, s3, 229376
    s_lshl_b32 s3, s3, 7
    s_add_u32 s13, s3, s85
    s_add_u32 s12, s3, s84
    s_add_u32 s89, s89, s86
    s_add_u32 m0, s93, 40960
    s_nop 0
    buffer_load_dwordx4 v6, s[48:51], s12 offen offset:0 lds
    s_mov_b32 s76, s46
    s_mov_b32 s77, s47
    s_mov_b32 s78, 0x10000000
    s_mov_b32 s79, 0x20000
    s_mov_b32 s98, 0
    s_mov_b32 s99, -1
    v_bfe_u32 v240, v2, 1, 3
    v_xor_b32 v240, v240, v3
    v_lshlrev_b32 v240, 4, v240
    v_lshl_add_u32 v240, v2, 7, v240
    v_add_u32 v22, s93, v240
    v_add_u32 v30, 32768, v240
    v_add_u32 v34, s94, v240
    buffer_load_dwordx4 v7, s[48:51], s12 offen offset:1024 lds
    v_xor_b32 v23, 32, v22
    v_xor_b32 v31, 32, v30
    v_xor_b32 v24, 64, v22
    v_xor_b32 v32, 64, v30
    v_xor_b32 v25, 96, v22
    v_xor_b32 v33, 96, v30
    v_bfe_u32 v240, v1, 2, 2
    v_and_b32 v241, 3, v1
    buffer_load_dwordx4 v8, s[48:51], s12 offen offset:2048 lds
    v_lshlrev_b32 v241, 3, v241
    v_bfe_u32 v242, v1, 4, 1
    v_lshl_add_u32 v241, v242, 5, v241
    v_lshl_add_u32 v242, v3, 3, v240
    v_lshl_add_u32 v242, v242, 8, v241
    v_lshl_add_u32 v242, v240, 6, v242
    v_add_u32 v26, 16384, v242
    v_xor_b32 v27, 64, v26
    v_xor_b32 v28, 128, v26
    buffer_load_dwordx4 v9, s[48:51], s12 offen offset:3072 lds
    v_xor_b32 v29, 192, v26
    v_lshrrev_b32 v242, 1, v240
    v_lshl_add_u32 v241, v242, 6, v241
    v_lshl_add_u32 v242, v3, 2, v240
    v_lshl_add_u32 v242, v242, 7, v241
    v_add_u32 v42, s94, v242
    s_mov_b32 s64, s40
    s_mov_b32 s65, s41
    s_mov_b32 s66, 0x1c0000
    s_mov_b32 s67, 0x20000
    s_mov_b32 s68, s26
    s_mov_b32 s69, s27
    s_mov_b32 s70, 0x80000
    s_mov_b32 s71, 0x20000
    s_lshr_b32 s3, s93, 1
    s_add_u32 m0, s3, 73728
    s_nop 0
    buffer_load_dwordx4 v10, s[56:59], s13 offen offset:0 lds
    s_mov_b32 s72, s28
    s_mov_b32 s73, s29
    s_mov_b32 s74, 0x80000
    s_mov_b32 s75, 0x20000
    s_mov_b32 s80, s42
    s_mov_b32 s81, s43
    s_mov_b32 s82, 0x400000
    s_mov_b32 s83, 0x20000
    s_lshl_b32 s3, s5, 13
    s_add_u32 s60, s46, s3
    s_addc_u32 s61, s47, 0
    s_add_u32 s60, s60, 262144
    s_addc_u32 s61, s61, 0
    s_mov_b32 s62, 8192
    s_mov_b32 s63, 0x20000
    s_lshr_b32 s3, s5, 3
    s_lshl_b32 s8, s4, 1
    s_or_b32 s8, s8, s3
    s_and_b32 s16, s9, 3
    s_cmp_eq_u32 s16, 3
    s_cselect_b32 s16, 0, s16
    s_cmp_eq_u32 s6, 3
    s_cselect_b32 s3, 1, 0
    s_lshl_b32 s24, s6, 2
    s_sub_u32 s24, s24, s3
    s_mul_i32 s25, s6, 3
    s_add_u32 s25, s25, s3
    buffer_load_dwordx4 v11, s[56:59], s13 offen offset:1024 lds
    s_lshl_b32 s21, s24, 13
    s_lshl_b32 s23, s25, 13
    s_add_u32 s23, s23, 4096
    s_add_u32 s22, s21, 24576
    s_add_u32 s3, s23, 8192
    s_cmp_lt_u32 s6, 2
    s_cselect_b32 s22, s22, s23
    s_cselect_b32 s23, s23, s3
    s_mul_i32 s21, s6, 28672
    s_mul_i32 s24, s6, 7
    s_lshr_b32 s24, s24, 1
    s_lshl_b32 s3, s9, 7
    s_lshl_b32 s18, s21, 4
    s_lshl_b32 s19, s22, 4
    s_lshl_b32 s20, s23, 4
    s_add_u32 s18, s18, s3
    s_add_u32 s19, s19, s3
    s_add_u32 s20, s20, s3
    s_lshl_b32 s3, s4, 2
    s_add_u32 s3, s3, s6
    s_mul_i32 s91, s3, 180224
    s_add_u32 s91, s91, 1048576
    s_waitcnt lgkmcnt(0)
    s_mul_i32 s10, s10, 0x9e3779b1
    s_add_u32 s10, s10, 0x7f4a7c15
    s_xor_b32 s3, s7, 2
    s_mul_i32 s89, s3, 229376
    s_lshl_b32 s3, s3, 7
    s_add_u32 s13, s3, s85
    s_add_u32 s12, s3, s84
    s_add_u32 s89, s89, s86
    s_add_u32 m0, s93, 81920
    s_nop 0
    buffer_load_dwordx4 v6, s[48:51], s12 offen offset:0 lds
    v_xor_b32 v35, 32, v34
    v_xor_b32 v36, 64, v34
    v_xor_b32 v37, 96, v34
    v_add_u32 v38, 81920, v34
    v_add_u32 v39, 81920, v35
    v_add_u32 v40, 81920, v36
    v_add_u32 v41, 81920, v37
    v_xor_b32 v43, 64, v42
    v_add_u32 v44, 81920, v42
    v_add_u32 v45, 81920, v43
    v_lshrrev_b32 v240, 3, v1
    v_and_b32 v241, 7, v1
    v_bfe_u32 v242, v1, 4, 1
    v_lshlrev_b32 v242, 2, v242
    v_xor_b32 v241, v241, v242
    v_lshlrev_b32 v241, 4, v241
    s_and_b32 s3, s6, 1
    s_lshl_b32 s3, s3, 6
    v_xor_b32 v241, s3, v241
    v_lshl_add_u32 v18, v240, 10, v241
    v_add_u32 v19, 7168, v18
    v_add_u32 v20, 14336, v18
    v_add_u32 v21, 21504, v18
    v_bfe_u32 v240, v2, 2, 1
    v_lshrrev_b32 v241, 3, v2
    v_and_b32 v242, 3, v2
    v_lshl_add_u32 v242, v241, 2, v242
    v_lshl_add_u32 v5, v240, 4, v242
    v_mov_b32 v194, 0
    v_mov_b32 v195, 0
    v_mov_b32 v198, 0
    v_mov_b32 v199, 0
    v_mov_b32 v202, 0
    v_mov_b32 v203, 0
    buffer_load_dwordx4 v7, s[48:51], s12 offen offset:1024 lds
    v_mov_b32 v206, 0
    v_mov_b32 v207, 0
    v_mov_b32 v210, 0
    v_mov_b32 v211, 0
    s_waitcnt vmcnt(8)
    v_lshlrev_b32 v212, 16, v212
    v_lshlrev_b32 v213, 16, v213
    v_lshlrev_b32 v214, 16, v214
    v_lshlrev_b32 v250, 16, v250
    v_mul_f32 v214, 0x3fb8aa3b, v214
    v_exp_f32 v214, v214
    s_nop 0
    v_cvt_pk_bf16_f32 v214, v214, v214
    v_and_b32 v214, 0xffff0000, v214
    v_mul_f32 v215, v214, v212
    v_mul_f32 v216, v214, v213
    v_mul_f32 v215, 0x3fb8aa3b, v215
    v_mul_f32 v216, 0.15915494, v216
    v_mul_f32 v217, 1.0, v215
    v_mul_f32 v218, 1.0, v216
    v_exp_f32 v217, v217
    v_fract_f32 v218, v218
    v_cos_f32 v46, v218
    v_sin_f32 v47, v218
    v_mul_f32 v46, v46, v217
    v_mul_f32 v47, v47, v217
    v_mul_f32 v217, 0x41800000, v215
    v_mul_f32 v218, 0x41800000, v216
    v_exp_f32 v217, v217
    buffer_load_dwordx4 v8, s[48:51], s12 offen offset:2048 lds
    v_fract_f32 v218, v218
    v_cos_f32 v49, v218
    v_sin_f32 v50, v218
    v_mul_f32 v49, v49, v217
    v_mul_f32 v50, v50, v217
    v_mul_f32 v217, 0x43800000, v215
    v_mul_f32 v218, 0x43800000, v216
    v_exp_f32 v217, v217
    v_fract_f32 v218, v218
    v_cos_f32 v54, v218
    v_sin_f32 v55, v218
    v_mul_f32 v54, v54, v217
    v_mul_f32 v55, v55, v217
    s_lshl_b32 s3, s6, 1
    v_add_u32 v219, s3, v3
    v_lshlrev_b32 v219, 4, v219
    v_cvt_f32_u32 v219, v219
    v_mul_f32 v217, v219, v215
    v_mul_f32 v218, v219, v216
    v_exp_f32 v217, v217
    v_fract_f32 v218, v218
    v_cos_f32 v52, v218
    v_sin_f32 v53, v218
    v_mul_f32 v52, v52, v217
    buffer_load_dwordx4 v9, s[48:51], s12 offen offset:3072 lds
    v_mul_f32 v53, v53, v217
    s_lshl_b32 s3, s6, 2
    v_add_u32 v219, s3, v3
    v_lshlrev_b32 v219, 7, v219
    v_cvt_f32_u32 v219, v219
    v_mul_f32 v217, v219, v215
    v_mul_f32 v218, v219, v216
    v_exp_f32 v217, v217
    v_fract_f32 v218, v218
    v_cos_f32 v56, v218
    v_sin_f32 v57, v218
    v_mul_f32 v56, v56, v217
    v_mul_f32 v57, v57, v217
    v_sub_f32 v48, 0, v47
    v_sub_f32 v51, 0, v50
    v_mul_f32 v217, v212, v212
    v_fmac_f32 v217, v213, v213
    v_rcp_f32 v217, v217
    v_subrev_f32 v218, 1.0, v46
    v_mul_f32 v58, v218, v212
    v_mul_f32 v60, v218, v213
    v_mul_f32 v217, 0x4038aa3b, v217
    v_fmac_f32 v58, v47, v213
    v_fmac_f32 v60, v48, v212
    v_mul_f32 v58, v58, v217
    v_mul_f32 v60, v60, v217
    v_sub_f32 v59, 0, v58
    v_mul_f32 v160, v58, v46
    s_lshr_b32 s3, s93, 1
    s_add_u32 m0, s3, 114688
    s_nop 0
    buffer_load_dwordx4 v10, s[56:59], s13 offen offset:0 lds
    v_mul_f32 v176, v58, v47
    v_fmac_f32 v160, v60, v47
    v_fma_f32 v176, -v60, v46, v176
    v_mul_f32 v161, v160, v46
    v_mul_f32 v177, v176, v46
    v_fmac_f32 v161, v176, v48
    v_fmac_f32 v177, v160, v47
    v_mul_f32 v162, v161, v46
    v_mul_f32 v178, v177, v46
    v_fmac_f32 v162, v177, v48
    v_fmac_f32 v178, v161, v47
    v_mul_f32 v163, v162, v46
    v_mul_f32 v179, v178, v46
    v_fmac_f32 v163, v178, v48
    v_fmac_f32 v179, v162, v47
    v_mul_f32 v164, v163, v46
    v_mul_f32 v180, v179, v46
    v_fmac_f32 v164, v179, v48
    v_fmac_f32 v180, v163, v47
    v_mul_f32 v165, v164, v46
    v_mul_f32 v181, v180, v46
    v_fmac_f32 v165, v180, v48
    v_fmac_f32 v181, v164, v47
    v_mul_f32 v166, v165, v46
    v_mul_f32 v182, v181, v46
    v_fmac_f32 v166, v181, v48
    v_fmac_f32 v182, v165, v47
    v_mul_f32 v167, v166, v46
    v_mul_f32 v183, v182, v46
    v_fmac_f32 v167, v182, v48
    v_fmac_f32 v183, v166, v47
    v_mul_f32 v168, v167, v46
    buffer_load_dwordx4 v11, s[56:59], s13 offen offset:1024 lds
    v_mul_f32 v184, v183, v46
    v_fmac_f32 v168, v183, v48
    v_fmac_f32 v184, v167, v47
    v_mul_f32 v169, v168, v46
    v_mul_f32 v185, v184, v46
    v_fmac_f32 v169, v184, v48
    v_fmac_f32 v185, v168, v47
    v_mul_f32 v170, v169, v46
    v_mul_f32 v186, v185, v46
    v_fmac_f32 v170, v185, v48
    v_fmac_f32 v186, v169, v47
    v_mul_f32 v171, v170, v46
    v_mul_f32 v187, v186, v46
    v_fmac_f32 v171, v186, v48
    v_fmac_f32 v187, v170, v47
    v_mul_f32 v172, v171, v46
    v_mul_f32 v188, v187, v46
    v_fmac_f32 v172, v187, v48
    v_fmac_f32 v188, v171, v47
    v_mul_f32 v173, v172, v46
    v_mul_f32 v189, v188, v46
    v_fmac_f32 v173, v188, v48
    v_fmac_f32 v189, v172, v47
    v_mul_f32 v174, v173, v46
    v_mul_f32 v190, v189, v46
    v_fmac_f32 v174, v189, v48
    v_fmac_f32 v190, v173, v47
    v_mul_f32 v175, v174, v46
    v_mul_f32 v191, v190, v46
    v_fmac_f32 v175, v190, v48
    v_fmac_f32 v191, v174, v47
    v_lshlrev_b32 v242, 10, v3
    v_lshl_add_u32 v242, v2, 4, v242
    buffer_load_dwordx4 v[232:235], v242, s[48:51], s11 offen
    buffer_load_dwordx4 v[236:239], v242, s[48:51], s11 offen offset:512
    s_and_b32 s12, s92, 15
    s_lshl_b32 s12, s12, 15
    s_add_u32 s12, s12, s94
    buffer_load_dwordx4 v[128:131], v4, s[36:39], s12 offen offset:0 nt
    buffer_load_dwordx4 v[132:135], v4, s[36:39], s12 offen offset:1024 nt
    buffer_load_dwordx4 v[136:139], v4, s[36:39], s12 offen offset:2048 nt
    buffer_load_dwordx4 v[140:143], v4, s[36:39], s12 offen offset:3072 nt
    s_add_u32 s12, s12, 4096
    buffer_load_dwordx4 v[144:147], v4, s[36:39], s12 offen offset:0 nt
    buffer_load_dwordx4 v[148:151], v4, s[36:39], s12 offen offset:1024 nt
    buffer_load_dwordx4 v[152:155], v4, s[36:39], s12 offen offset:2048 nt
    buffer_load_dwordx4 v[156:159], v4, s[36:39], s12 offen offset:3072 nt
    s_min_u32 s12, s92, 27
    s_lshl_b32 s12, s12, 7
    s_mul_i32 s3, s6, 458752
    s_add_u32 s12, s12, s3
    v_lshrrev_b32 v244, 3, v1
    v_mul_u32_u24 v244, 3584, v244
    v_and_b32 v245, 7, v1
    v_lshl_add_u32 v244, v245, 4, v244
    buffer_load_dwordx4 v[64:67], v244, s[52:55], s12 offen nt
    s_add_u32 s12, s12, 28672
    buffer_load_dwordx4 v[68:71], v244, s[52:55], s12 offen nt
    s_add_u32 s12, s12, 28672
    buffer_load_dwordx4 v[72:75], v244, s[52:55], s12 offen nt
    s_add_u32 s12, s12, 28672
    buffer_load_dwordx4 v[76:79], v244, s[52:55], s12 offen nt
    s_add_u32 s12, s12, 28672
    buffer_load_dwordx4 v[80:83], v244, s[52:55], s12 offen nt
    s_add_u32 s12, s12, 28672
    buffer_load_dwordx4 v[84:87], v244, s[52:55], s12 offen nt
    s_add_u32 s12, s12, 28672
    buffer_load_dwordx4 v[88:91], v244, s[52:55], s12 offen nt
    s_add_u32 s12, s12, 28672
    buffer_load_dwordx4 v[92:95], v244, s[52:55], s12 offen nt
    s_add_u32 s12, s12, 28672
    buffer_load_dwordx4 v[96:99], v244, s[52:55], s12 offen nt
    s_add_u32 s12, s12, 28672
    buffer_load_dwordx4 v[100:103], v244, s[52:55], s12 offen nt
    s_add_u32 s12, s12, 28672
    buffer_load_dwordx4 v[104:107], v244, s[52:55], s12 offen nt
    s_add_u32 s12, s12, 28672
    buffer_load_dwordx4 v[108:111], v244, s[52:55], s12 offen nt
    s_add_u32 s12, s12, 28672
    buffer_load_dwordx4 v[112:115], v244, s[52:55], s12 offen nt
    s_add_u32 s12, s12, 28672
    buffer_load_dwordx4 v[116:119], v244, s[52:55], s12 offen nt
    s_add_u32 s12, s12, 28672
    buffer_load_dwordx4 v[120:123], v244, s[52:55], s12 offen nt
    s_add_u32 s12, s12, 28672
    buffer_load_dwordx4 v[124:127], v244, s[52:55], s12 offen nt
    s_add_u32 s12, s12, 28672
    v_mov_b32 v228, 0
    v_mov_b32 v229, 0
    s_mov_b32 s15, 0x3f803f80
    s_waitcnt vmcnt(24)
    v_lshlrev_b32 v230, 16, v232
    v_and_b32 v231, 0xffff0000, v232
    v_add_f32 v228, v228, v230
    v_fmac_f32 v229, v230, v230
    v_add_f32 v228, v228, v231
    v_fmac_f32 v229, v231, v231
    v_lshlrev_b32 v230, 16, v233
    v_and_b32 v231, 0xffff0000, v233
    v_add_f32 v228, v228, v230
    v_fmac_f32 v229, v230, v230
    v_add_f32 v228, v228, v231
    v_fmac_f32 v229, v231, v231
    v_lshlrev_b32 v230, 16, v234
    v_and_b32 v231, 0xffff0000, v234
    v_add_f32 v228, v228, v230
    v_fmac_f32 v229, v230, v230
    v_add_f32 v228, v228, v231
    v_fmac_f32 v229, v231, v231
    v_lshlrev_b32 v230, 16, v235
    v_and_b32 v231, 0xffff0000, v235
    v_add_f32 v228, v228, v230
    v_fmac_f32 v229, v230, v230
    v_add_f32 v228, v228, v231
    v_fmac_f32 v229, v231, v231
    v_lshlrev_b32 v230, 16, v236
    v_and_b32 v231, 0xffff0000, v236
    v_add_f32 v228, v228, v230
    v_fmac_f32 v229, v230, v230
    v_add_f32 v228, v228, v231
    v_fmac_f32 v229, v231, v231
    v_lshlrev_b32 v230, 16, v237
    v_and_b32 v231, 0xffff0000, v237
    v_add_f32 v228, v228, v230
    v_fmac_f32 v229, v230, v230
    v_add_f32 v228, v228, v231
    v_fmac_f32 v229, v231, v231
    v_lshlrev_b32 v230, 16, v238
    v_and_b32 v231, 0xffff0000, v238
    v_add_f32 v228, v228, v230
    v_fmac_f32 v229, v230, v230
    v_add_f32 v228, v228, v231
    v_fmac_f32 v229, v231, v231
    v_lshlrev_b32 v230, 16, v239
    v_and_b32 v231, 0xffff0000, v239
    v_add_f32 v228, v228, v230
    v_fmac_f32 v229, v230, v230
    v_add_f32 v228, v228, v231
    v_fmac_f32 v229, v231, v231
    s_nop 0
    v_add_f32_dpp v228, v228, v228 row_ror:8 row_mask:0xf bank_mask:0xf
    v_add_f32_dpp v229, v229, v229 row_ror:8 row_mask:0xf bank_mask:0xf
    s_nop 0
    v_add_f32_dpp v228, v228, v228 row_ror:4 row_mask:0xf bank_mask:0xf
    v_add_f32_dpp v229, v229, v229 row_ror:4 row_mask:0xf bank_mask:0xf
    s_nop 0
    v_add_f32_dpp v228, v228, v228 row_ror:2 row_mask:0xf bank_mask:0xf
    v_add_f32_dpp v229, v229, v229 row_ror:2 row_mask:0xf bank_mask:0xf
    s_nop 0
    v_add_f32_dpp v228, v228, v228 row_ror:1 row_mask:0xf bank_mask:0xf
    v_add_f32_dpp v229, v229, v229 row_ror:1 row_mask:0xf bank_mask:0xf
    v_mov_b32 v230, v228
    v_mov_b32 v231, v229
    s_nop 0
    v_permlane16_swap_b32 v228, v230
    v_permlane16_swap_b32 v229, v231
    v_add_f32 v228, v228, v230
    v_add_f32 v229, v229, v231
    v_mul_f32 v228, 0x3b000000, v228
    v_mul_f32 v229, 0x3b000000, v229
    v_fma_f32 v229, -v228, v228, v229
    v_max_f32 v229, 0, v229
    v_cvt_pk_bf16_f32 v229, v229, v229
    v_and_b32 v229, 0xffff0000, v229
    v_add_f32 v229, 0x3727c5ac, v229
    v_cvt_pk_bf16_f32 v229, v229, v229
    v_and_b32 v229, 0xffff0000, v229
    v_sqrt_f32 v229, v229
    s_nop 0
    v_cvt_pk_bf16_f32 v232, v228, v229
    v_mov_b32 v233, s10
    v_lshlrev_b32 v230, 3, v3
    s_lshr_b32 s11, s11, 7
    s_add_u32 s11, s11, 65536
    s_mov_b32 exec_lo, 1
    s_mov_b32 exec_hi, 1
    buffer_store_dwordx2 v[232:233], v230, s[76:79], s11 offen sc1
    s_mov_b64 exec, -1
    s_mov_b32 s12, 0x3f803f80
    v_mov_b32 v228, 0
    v_mov_b32 v229, 0
    v_mov_b32 v230, 0
    v_mov_b32 v231, 0
    v_mov_b32 v232, 0
    v_mov_b32 v233, 0
    v_mov_b32 v234, 0
    v_mov_b32 v235, 0
    v_bfe_u32 v236, v1, 4, 1
    v_lshl_add_u32 v236, v236, 1, v3
    s_waitcnt vmcnt(17)
    v_dot2c_f32_bf16 v228, s12, v128
    v_dot2c_f32_bf16 v229, s12, v132
    v_dot2c_f32_bf16 v230, s12, v136
    v_dot2c_f32_bf16 v231, s12, v140
    v_dot2c_f32_bf16 v232, s12, v144
    v_dot2c_f32_bf16 v233, s12, v148
    v_dot2c_f32_bf16 v234, s12, v152
    v_dot2c_f32_bf16 v235, s12, v156
    v_dot2c_f32_bf16 v228, s12, v129
    v_dot2c_f32_bf16 v229, s12, v133
    v_dot2c_f32_bf16 v230, s12, v137
    v_dot2c_f32_bf16 v231, s12, v141
    v_dot2c_f32_bf16 v232, s12, v145
    v_dot2c_f32_bf16 v233, s12, v149
    v_dot2c_f32_bf16 v234, s12, v153
    v_dot2c_f32_bf16 v235, s12, v157
    v_dot2c_f32_bf16 v228, s12, v130
    v_dot2c_f32_bf16 v229, s12, v134
    v_dot2c_f32_bf16 v230, s12, v138
    v_dot2c_f32_bf16 v231, s12, v142
    v_dot2c_f32_bf16 v232, s12, v146
    v_dot2c_f32_bf16 v233, s12, v150
    v_dot2c_f32_bf16 v234, s12, v154
    v_dot2c_f32_bf16 v235, s12, v158
    v_dot2c_f32_bf16 v228, s12, v131
    v_dot2c_f32_bf16 v229, s12, v135
    v_dot2c_f32_bf16 v230, s12, v139
    v_dot2c_f32_bf16 v231, s12, v143
    v_dot2c_f32_bf16 v232, s12, v147
    v_dot2c_f32_bf16 v233, s12, v151
    v_dot2c_f32_bf16 v234, s12, v155
    v_dot2c_f32_bf16 v235, s12, v159
    v_permlane32_swap_b32 v228, v229
    v_permlane32_swap_b32 v230, v231
    v_permlane32_swap_b32 v232, v233
    v_permlane32_swap_b32 v234, v235
    v_add_f32 v228, v228, v229
    v_add_f32 v230, v230, v231
    v_add_f32 v232, v232, v233
    v_add_f32 v234, v234, v235
    v_permlane16_swap_b32 v228, v230
    s_nop 0
    v_permlane16_swap_b32 v232, v234
    v_add_f32 v228, v228, v230
    v_add_f32 v232, v232, v234
    s_nop 0
    v_add_f32_dpp v228, v228, v228 row_ror:8 row_mask:0xf bank_mask:0xf
    v_add_f32_dpp v232, v232, v232 row_ror:8 row_mask:0xf bank_mask:0xf
    s_nop 0
    v_add_f32_dpp v228, v228, v228 row_ror:4 row_mask:0xf bank_mask:0xf
    v_add_f32_dpp v232, v232, v232 row_ror:4 row_mask:0xf bank_mask:0xf
    s_nop 0
    v_add_f32_dpp v228, v228, v228 row_ror:2 row_mask:0xf bank_mask:0xf
    v_add_f32_dpp v232, v232, v232 row_ror:2 row_mask:0xf bank_mask:0xf
    s_nop 0
    v_add_f32_dpp v228, v228, v228 row_ror:1 row_mask:0xf bank_mask:0xf
    v_add_f32_dpp v232, v232, v232 row_ror:1 row_mask:0xf bank_mask:0xf
    v_and_b32 v237, 1, v1
    v_cmp_eq_u32 vcc, 1, v237
    v_lshl_add_u32 v237, v237, 2, v236
    v_lshlrev_b32 v237, 3, v237
    v_cndmask_b32 v228, v228, v232, vcc
    s_lshl_b32 s14, s92, 8
    s_lshl_b32 s3, s6, 6
    s_add_u32 s14, s14, s3
    s_add_u32 s14, s14, 210944
    v_cvt_pk_bf16_f32 v229, v228, v228
    v_and_b32 v229, 0xffff0000, v229
    v_sub_f32 v229, v228, v229
    v_cvt_pk_bf16_f32 v228, v228, v229
    v_mov_b32 v229, s10
    buffer_store_dwordx2 v[228:229], v237, s[76:79], s14 offen sc1
    s_mov_b32 s14, 0x00003f80
    s_mov_b32 s15, 0x3f800000
    v_mov_b32 v228, 0
    v_mov_b32 v229, 0
    v_mov_b32 v230, 0
    v_mov_b32 v231, 0
    v_mov_b32 v232, 0
    v_mov_b32 v233, 0
    v_mov_b32 v234, 0
    v_mov_b32 v235, 0
    s_waitcnt vmcnt(17)
    v_dot2c_f32_bf16 v228, s14, v64
    v_dot2c_f32_bf16 v229, s15, v64
    v_dot2c_f32_bf16 v230, s14, v65
    v_dot2c_f32_bf16 v231, s15, v65
    v_dot2c_f32_bf16 v232, s14, v66
    v_dot2c_f32_bf16 v233, s15, v66
    v_dot2c_f32_bf16 v234, s14, v67
    v_dot2c_f32_bf16 v235, s15, v67
    s_waitcnt vmcnt(16)
    v_dot2c_f32_bf16 v228, s14, v68
    v_dot2c_f32_bf16 v229, s15, v68
    v_dot2c_f32_bf16 v230, s14, v69
    v_dot2c_f32_bf16 v231, s15, v69
    v_dot2c_f32_bf16 v232, s14, v70
    v_dot2c_f32_bf16 v233, s15, v70
    v_dot2c_f32_bf16 v234, s14, v71
    v_dot2c_f32_bf16 v235, s15, v71
    s_waitcnt vmcnt(15)
    v_dot2c_f32_bf16 v228, s14, v72
    v_dot2c_f32_bf16 v229, s15, v72
    v_dot2c_f32_bf16 v230, s14, v73
    v_dot2c_f32_bf16 v231, s15, v73
    v_dot2c_f32_bf16 v232, s14, v74
    v_dot2c_f32_bf16 v233, s15, v74
    v_dot2c_f32_bf16 v234, s14, v75
    v_dot2c_f32_bf16 v235, s15, v75
    s_waitcnt vmcnt(14)
    v_dot2c_f32_bf16 v228, s14, v76
    v_dot2c_f32_bf16 v229, s15, v76
    v_dot2c_f32_bf16 v230, s14, v77
    v_dot2c_f32_bf16 v231, s15, v77
    v_dot2c_f32_bf16 v232, s14, v78
    v_dot2c_f32_bf16 v233, s15, v78
    v_dot2c_f32_bf16 v234, s14, v79
    v_dot2c_f32_bf16 v235, s15, v79
    s_waitcnt vmcnt(13)
    v_dot2c_f32_bf16 v228, s14, v80
    v_dot2c_f32_bf16 v229, s15, v80
    v_dot2c_f32_bf16 v230, s14, v81
    v_dot2c_f32_bf16 v231, s15, v81
    v_dot2c_f32_bf16 v232, s14, v82
    v_dot2c_f32_bf16 v233, s15, v82
    v_dot2c_f32_bf16 v234, s14, v83
    v_dot2c_f32_bf16 v235, s15, v83
    s_waitcnt vmcnt(12)
    v_dot2c_f32_bf16 v228, s14, v84
    v_dot2c_f32_bf16 v229, s15, v84
    v_dot2c_f32_bf16 v230, s14, v85
    v_dot2c_f32_bf16 v231, s15, v85
    v_dot2c_f32_bf16 v232, s14, v86
    v_dot2c_f32_bf16 v233, s15, v86
    v_dot2c_f32_bf16 v234, s14, v87
    v_dot2c_f32_bf16 v235, s15, v87
    s_waitcnt vmcnt(11)
    v_dot2c_f32_bf16 v228, s14, v88
    v_dot2c_f32_bf16 v229, s15, v88
    v_dot2c_f32_bf16 v230, s14, v89
    v_dot2c_f32_bf16 v231, s15, v89
    v_dot2c_f32_bf16 v232, s14, v90
    v_dot2c_f32_bf16 v233, s15, v90
    v_dot2c_f32_bf16 v234, s14, v91
    v_dot2c_f32_bf16 v235, s15, v91
    s_waitcnt vmcnt(10)
    v_dot2c_f32_bf16 v228, s14, v92
    v_dot2c_f32_bf16 v229, s15, v92
    v_dot2c_f32_bf16 v230, s14, v93
    v_dot2c_f32_bf16 v231, s15, v93
    v_dot2c_f32_bf16 v232, s14, v94
    v_dot2c_f32_bf16 v233, s15, v94
    v_dot2c_f32_bf16 v234, s14, v95
    v_dot2c_f32_bf16 v235, s15, v95
    s_waitcnt vmcnt(9)
    v_dot2c_f32_bf16 v228, s14, v96
    v_dot2c_f32_bf16 v229, s15, v96
    v_dot2c_f32_bf16 v230, s14, v97
    v_dot2c_f32_bf16 v231, s15, v97
    v_dot2c_f32_bf16 v232, s14, v98
    v_dot2c_f32_bf16 v233, s15, v98
    v_dot2c_f32_bf16 v234, s14, v99
    v_dot2c_f32_bf16 v235, s15, v99
    s_waitcnt vmcnt(8)
    v_dot2c_f32_bf16 v228, s14, v100
    v_dot2c_f32_bf16 v229, s15, v100
    v_dot2c_f32_bf16 v230, s14, v101
    v_dot2c_f32_bf16 v231, s15, v101
    v_dot2c_f32_bf16 v232, s14, v102
    v_dot2c_f32_bf16 v233, s15, v102
    v_dot2c_f32_bf16 v234, s14, v103
    v_dot2c_f32_bf16 v235, s15, v103
    s_waitcnt vmcnt(7)
    v_dot2c_f32_bf16 v228, s14, v104
    v_dot2c_f32_bf16 v229, s15, v104
    v_dot2c_f32_bf16 v230, s14, v105
    v_dot2c_f32_bf16 v231, s15, v105
    v_dot2c_f32_bf16 v232, s14, v106
    v_dot2c_f32_bf16 v233, s15, v106
    v_dot2c_f32_bf16 v234, s14, v107
    v_dot2c_f32_bf16 v235, s15, v107
    s_waitcnt vmcnt(6)
    v_dot2c_f32_bf16 v228, s14, v108
    v_dot2c_f32_bf16 v229, s15, v108
    v_dot2c_f32_bf16 v230, s14, v109
    v_dot2c_f32_bf16 v231, s15, v109
    v_dot2c_f32_bf16 v232, s14, v110
    v_dot2c_f32_bf16 v233, s15, v110
    v_dot2c_f32_bf16 v234, s14, v111
    v_dot2c_f32_bf16 v235, s15, v111
    s_waitcnt vmcnt(5)
    v_dot2c_f32_bf16 v228, s14, v112
    v_dot2c_f32_bf16 v229, s15, v112
    v_dot2c_f32_bf16 v230, s14, v113
    v_dot2c_f32_bf16 v231, s15, v113
    v_dot2c_f32_bf16 v232, s14, v114
    v_dot2c_f32_bf16 v233, s15, v114
    v_dot2c_f32_bf16 v234, s14, v115
    v_dot2c_f32_bf16 v235, s15, v115
    s_waitcnt vmcnt(4)
    v_dot2c_f32_bf16 v228, s14, v116
    v_dot2c_f32_bf16 v229, s15, v116
    v_dot2c_f32_bf16 v230, s14, v117
    v_dot2c_f32_bf16 v231, s15, v117
    v_dot2c_f32_bf16 v232, s14, v118
    v_dot2c_f32_bf16 v233, s15, v118
    v_dot2c_f32_bf16 v234, s14, v119
    v_dot2c_f32_bf16 v235, s15, v119
    s_waitcnt vmcnt(3)
    v_dot2c_f32_bf16 v228, s14, v120
    v_dot2c_f32_bf16 v229, s15, v120
    v_dot2c_f32_bf16 v230, s14, v121
    v_dot2c_f32_bf16 v231, s15, v121
    v_dot2c_f32_bf16 v232, s14, v122
    v_dot2c_f32_bf16 v233, s15, v122
    v_dot2c_f32_bf16 v234, s14, v123
    v_dot2c_f32_bf16 v235, s15, v123
    s_waitcnt vmcnt(2)
    v_dot2c_f32_bf16 v228, s14, v124
    v_dot2c_f32_bf16 v229, s15, v124
    v_dot2c_f32_bf16 v230, s14, v125
    v_dot2c_f32_bf16 v231, s15, v125
    v_dot2c_f32_bf16 v232, s14, v126
    v_dot2c_f32_bf16 v233, s15, v126
    v_dot2c_f32_bf16 v234, s14, v127
    v_dot2c_f32_bf16 v235, s15, v127
    v_add_f32_dpp v228, v228, v228 row_ror:8 row_mask:0xf bank_mask:0xf
    v_add_f32_dpp v229, v229, v229 row_ror:8 row_mask:0xf bank_mask:0xf
    v_add_f32_dpp v230, v230, v230 row_ror:8 row_mask:0xf bank_mask:0xf
    v_add_f32_dpp v231, v231, v231 row_ror:8 row_mask:0xf bank_mask:0xf
    v_add_f32_dpp v232, v232, v232 row_ror:8 row_mask:0xf bank_mask:0xf
    v_add_f32_dpp v233, v233, v233 row_ror:8 row_mask:0xf bank_mask:0xf
    v_add_f32_dpp v234, v234, v234 row_ror:8 row_mask:0xf bank_mask:0xf
    v_add_f32_dpp v235, v235, v235 row_ror:8 row_mask:0xf bank_mask:0xf
    v_permlane32_swap_b32 v228, v229
    v_permlane32_swap_b32 v230, v231
    v_permlane32_swap_b32 v232, v233
    v_permlane32_swap_b32 v234, v235
    v_add_f32 v228, v228, v229
    v_add_f32 v230, v230, v231
    v_add_f32 v232, v232, v233
    v_add_f32 v234, v234, v235
    v_permlane16_swap_b32 v228, v230
    s_nop 0
    v_permlane16_swap_b32 v232, v234
    v_add_f32 v228, v228, v230
    v_add_f32 v232, v232, v234
    v_and_b32 v237, 7, v1
    v_lshl_add_u32 v237, v237, 3, v236
    v_lshlrev_b32 v237, 2, v237
    s_lshl_b32 s3, s6, 8
    s_add_u32 s3, s3, 16384
    v_add_u32 v237, s3, v237
    ds_write2_b32 v237, v228, v232 offset0:0 offset1:4
    v_lshlrev_b32 v237, 2, v1
    v_add_u32 v237, 16384, v237
    s_waitcnt lgkmcnt(0)
    s_barrier
    ds_read_b32 v228, v237 offset:0
    ds_read_b32 v229, v237 offset:256
    ds_read_b32 v230, v237 offset:512
    ds_read_b32 v231, v237 offset:768
    s_min_u32 s14, s92, 27
    s_lshl_b32 s14, s14, 9
    s_add_u32 s14, s14, 196608
    v_lshlrev_b32 v238, 3, v1
    s_waitcnt lgkmcnt(0)
    v_add_f32 v228, v228, v229
    v_add_f32 v230, v230, v231
    v_add_f32 v228, v228, v230
    v_cvt_pk_bf16_f32 v229, v228, v228
    v_and_b32 v229, 0xffff0000, v229
    v_sub_f32 v229, v228, v229
    v_cvt_pk_bf16_f32 v228, v228, v229
    v_mov_b32 v229, s10
    buffer_store_dwordx2 v[228:229], v238, s[76:79], s14 offen sc1
    s_barrier
    ds_read_b128 a[128:131], v22 offset:0
    ds_read_b128 a[132:135], v30 offset:0
    ds_read_b128 a[136:139], v30 offset:4096
    s_waitcnt lgkmcnt(0)
    v_mfma_f32_32x32x16_bf16 v[128:143], a[128:131], a[132:135], 0
    ds_read_b128 a[156:159], v23 offset:0
    ds_read_b128 a[160:163], v31 offset:0
    s_and_b32 s3, s4, 3
    s_lshl_b32 s3, s3, 2
    s_add_u32 s3, s3, s6
    s_mul_i32 s87, s3, 114688
    s_add_u32 s87, s87, 384
    v_lshrrev_b32 v243, 2, v1
    v_lshlrev_b32 v243, 10, v243
    buffer_load_dword a255, v243, s[64:67], s87 offen
    v_mfma_f32_32x32x16_bf16 v[144:159], a[128:131], a[136:139], 0
    ds_read_b128 a[164:167], v31 offset:4096
    s_waitcnt lgkmcnt(0)
    v_mfma_f32_32x32x16_bf16 v[128:143], a[156:159], a[160:163], v[128:143]
    ds_read_b128 a[128:131], v24 offset:0
    ds_read_b128 a[132:135], v32 offset:0
    v_mfma_f32_32x32x16_bf16 v[144:159], a[156:159], a[164:167], v[144:159]
    ds_read_b128 a[136:139], v32 offset:4096
    s_waitcnt lgkmcnt(0)
    v_mfma_f32_32x32x16_bf16 v[128:143], a[128:131], a[132:135], v[128:143]
    ds_read_b128 a[156:159], v25 offset:0
    ds_read_b128 a[160:163], v33 offset:0
    v_mfma_f32_32x32x16_bf16 v[144:159], a[128:131], a[136:139], v[144:159]
    ds_read_b128 a[164:167], v33 offset:4096
    s_barrier
    s_waitcnt lgkmcnt(0)
    v_mfma_f32_32x32x16_bf16 v[128:143], a[156:159], a[160:163], v[128:143]
    ds_read_b128 a[128:131], v22 offset:40960
    ds_read_b128 a[132:135], v30 offset:40960
    s_xor_b32 s3, s7, 3
    s_mul_i32 s89, s3, 229376
    s_lshl_b32 s3, s3, 7
    s_add_u32 s13, s3, s85
    s_add_u32 s12, s3, s84
    s_add_u32 s89, s89, s86
    s_add_u32 m0, s93, 122880
    s_nop 0
    buffer_load_dwordx4 v6, s[48:51], s12 offen offset:0 lds
    v_mfma_f32_32x32x16_bf16 v[144:159], a[156:159], a[164:167], v[144:159]
    ds_read_b128 a[136:139], v30 offset:45056
    buffer_load_dwordx4 v7, s[48:51], s12 offen offset:1024 lds
    s_waitcnt lgkmcnt(0)
    v_mfma_f32_32x32x16_bf16 v[128:143], a[128:131], a[132:135], v[128:143]
    ds_read_b128 a[156:159], v23 offset:40960
    ds_read_b128 a[160:163], v31 offset:40960
    buffer_load_dwordx4 v8, s[48:51], s12 offen offset:2048 lds
    v_mfma_f32_32x32x16_bf16 v[144:159], a[128:131], a[136:139], v[144:159]
    ds_read_b128 a[164:167], v31 offset:45056
    buffer_load_dwordx4 v9, s[48:51], s12 offen offset:3072 lds
    s_waitcnt lgkmcnt(0)
    v_mfma_f32_32x32x16_bf16 v[128:143], a[156:159], a[160:163], v[128:143]
    ds_read_b128 a[128:131], v24 offset:40960
    ds_read_b128 a[132:135], v32 offset:40960
    s_lshr_b32 s3, s93, 1
    s_add_u32 m0, s3, 155648
    s_nop 0
    buffer_load_dwordx4 v10, s[56:59], s13 offen offset:0 lds
    v_mfma_f32_32x32x16_bf16 v[144:159], a[156:159], a[164:167], v[144:159]
    ds_read_b128 a[136:139], v32 offset:45056
    buffer_load_dwordx4 v11, s[56:59], s13 offen offset:1024 lds
    s_waitcnt lgkmcnt(0)
    v_mfma_f32_32x32x16_bf16 v[128:143], a[128:131], a[132:135], v[128:143]
    ds_read_b128 a[156:159], v25 offset:40960
    ds_read_b128 a[160:163], v33 offset:40960
    s_add_u32 s87, s87, 16384
    buffer_load_dword a255, v243, s[64:67], s87 offen
    v_mfma_f32_32x32x16_bf16 v[144:159], a[128:131], a[136:139], v[144:159]
    ds_read_b128 a[164:167], v33 offset:45056
    s_barrier
    s_waitcnt lgkmcnt(0)
    v_mfma_f32_32x32x16_bf16 v[128:143], a[156:159], a[160:163], v[128:143]
    v_add_u32 v22, 0x14000, v22
    ds_read_b128 a[128:131], v22 offset:0
    v_add_u32 v30, 0x14000, v30
    ds_read_b128 a[132:135], v30 offset:0
    s_xor_b32 s3, s7, 4
    s_mul_i32 s89, s3, 229376
    s_lshl_b32 s3, s3, 7
    s_add_u32 s13, s3, s85
    s_add_u32 s12, s3, s84
    s_add_u32 s89, s89, s86
    s_add_u32 m0, s93, 0
    s_nop 0
    buffer_load_dwordx4 v6, s[48:51], s12 offen offset:0 lds
    v_mfma_f32_32x32x16_bf16 v[144:159], a[156:159], a[164:167], v[144:159]
    ds_read_b128 a[136:139], v30 offset:4096
    buffer_load_dwordx4 v7, s[48:51], s12 offen offset:1024 lds
    s_waitcnt lgkmcnt(0)
    v_mfma_f32_32x32x16_bf16 v[128:143], a[128:131], a[132:135], v[128:143]
    v_add_u32 v23, 0x14000, v23
    ds_read_b128 a[156:159], v23 offset:0
    v_add_u32 v31, 0x14000, v31
    ds_read_b128 a[160:163], v31 offset:0
    buffer_load_dwordx4 v8, s[48:51], s12 offen offset:2048 lds
    v_mfma_f32_32x32x16_bf16 v[144:159], a[128:131], a[136:139], v[144:159]
    ds_read_b128 a[164:167], v31 offset:4096
    buffer_load_dwordx4 v9, s[48:51], s12 offen offset:3072 lds
    s_waitcnt lgkmcnt(0)
    v_mfma_f32_32x32x16_bf16 v[128:143], a[156:159], a[160:163], v[128:143]
    v_add_u32 v24, 0x14000, v24
    ds_read_b128 a[128:131], v24 offset:0
    v_add_u32 v32, 0x14000, v32
    ds_read_b128 a[132:135], v32 offset:0
    s_lshr_b32 s3, s93, 1
    s_add_u32 m0, s3, 32768
    s_nop 0
    buffer_load_dwordx4 v10, s[56:59], s13 offen offset:0 lds
    v_mfma_f32_32x32x16_bf16 v[144:159], a[156:159], a[164:167], v[144:159]
    ds_read_b128 a[136:139], v32 offset:4096
    buffer_load_dwordx4 v11, s[56:59], s13 offen offset:1024 lds
    s_waitcnt lgkmcnt(0)
    v_mfma_f32_32x32x16_bf16 v[128:143], a[128:131], a[132:135], v[128:143]
    v_add_u32 v25, 0x14000, v25
    ds_read_b128 a[156:159], v25 offset:0
    v_add_u32 v33, 0x14000, v33
    ds_read_b128 a[160:163], v33 offset:0
    s_xor_b32 s14, s2, 0
    s_lshl_b32 s14, s14, 2
    s_add_u32 s14, s14, s6
    s_mul_i32 s3, s14, 1792
    v_lshrrev_b32 v246, 2, v1
    v_min_u32 v247, 13, v246
    v_lshlrev_b32 v247, 7, v247
    buffer_load_dword a255, v247, s[64:67], s3 offen
    v_mfma_f32_32x32x16_bf16 v[144:159], a[128:131], a[136:139], v[144:159]
    ds_read_b128 a[164:167], v33 offset:4096
    s_add_u32 s87, s87, 16384
    buffer_load_dword a255, v243, s[64:67], s87 offen
    s_waitcnt vmcnt(9)
    s_barrier
    s_waitcnt lgkmcnt(0)
    v_mfma_f32_32x32x16_bf16 v[128:143], a[156:159], a[160:163], v[128:143]
    ds_read_b128 a[128:131], v22 offset:40960
    ds_read_b128 a[132:135], v30 offset:40960
    s_xor_b32 s3, s7, 5
    s_mul_i32 s89, s3, 229376
    s_lshl_b32 s3, s3, 7
    s_add_u32 s13, s3, s85
    s_add_u32 s12, s3, s84
    s_add_u32 s89, s89, s86
    s_add_u32 m0, s93, 40960
    s_nop 0
    buffer_load_dwordx4 v6, s[48:51], s12 offen offset:0 lds
    buffer_load_dwordx4 v7, s[48:51], s12 offen offset:1024 lds
    v_mfma_f32_32x32x16_bf16 v[144:159], a[156:159], a[164:167], v[144:159]
    ds_read_b128 a[136:139], v30 offset:45056
    buffer_load_dwordx4 v8, s[48:51], s12 offen offset:2048 lds
    s_waitcnt lgkmcnt(0)
    v_mfma_f32_32x32x16_bf16 v[128:143], a[128:131], a[132:135], v[128:143]
    ds_read_b128 a[156:159], v23 offset:40960
    ds_read_b128 a[160:163], v31 offset:40960
    buffer_load_dwordx4 v9, s[48:51], s12 offen offset:3072 lds
    v_mfma_f32_32x32x16_bf16 v[144:159], a[128:131], a[136:139], v[144:159]
    ds_read_b128 a[164:167], v31 offset:45056
    s_lshr_b32 s3, s93, 1
    s_add_u32 m0, s3, 73728
    s_nop 0
    buffer_load_dwordx4 v10, s[56:59], s13 offen offset:0 lds
    s_waitcnt lgkmcnt(0)
    v_mfma_f32_32x32x16_bf16 v[128:143], a[156:159], a[160:163], v[128:143]
    ds_read_b128 a[128:131], v24 offset:40960
    ds_read_b128 a[132:135], v32 offset:40960
    buffer_load_dwordx4 v11, s[56:59], s13 offen offset:1024 lds
    v_mfma_f32_32x32x16_bf16 v[144:159], a[156:159], a[164:167], v[144:159]
    ds_read_b128 a[136:139], v32 offset:45056
    s_lshl_b32 s14, s2, 2
    s_add_u32 s14, s14, s6
    s_lshl_b32 s14, s14, 9
    v_and_b32 v246, 3, v246
    v_lshlrev_b32 v246, 7, v246
    buffer_load_dword a255, v246, s[68:71], s14 offen
    s_waitcnt lgkmcnt(0)
    v_mfma_f32_32x32x16_bf16 v[128:143], a[128:131], a[132:135], v[128:143]
    ds_read_b128 a[156:159], v25 offset:40960
    ds_read_b128 a[160:163], v33 offset:40960
    s_lshl_b32 s14, s2, 2
    s_add_u32 s14, s14, s6
    s_lshl_b32 s14, s14, 9
    buffer_load_dword a255, v246, s[72:75], s14 offen
    v_mfma_f32_32x32x16_bf16 v[144:159], a[128:131], a[136:139], v[144:159]
    ds_read_b128 a[164:167], v33 offset:45056
    s_add_u32 s87, s87, 16384
    buffer_load_dword a255, v243, s[64:67], s87 offen
    s_waitcnt vmcnt(11)
    s_barrier
    s_waitcnt lgkmcnt(0)
    v_mfma_f32_32x32x16_bf16 v[128:143], a[156:159], a[160:163], v[128:143]
    v_add_u32 v22, 0xfffec000, v22
    ds_read_b128 a[128:131], v22 offset:0
    v_add_u32 v30, 0xfffec000, v30
    ds_read_b128 a[132:135], v30 offset:0
    s_nop 0
    v_mfma_f32_32x32x16_bf16 v[144:159], a[156:159], a[164:167], v[144:159]
    ds_read_b128 a[136:139], v30 offset:4096
    s_xor_b32 s3, s7, 6
    s_mul_i32 s89, s3, 229376
    s_lshl_b32 s3, s3, 7
    s_add_u32 s13, s3, s85
    s_add_u32 s12, s3, s84
    s_add_u32 s89, s89, s86
    s_add_u32 m0, s93, 81920
    s_nop 0
    buffer_load_dwordx4 v6, s[48:51], s12 offen offset:0 lds
    s_waitcnt lgkmcnt(0)
    v_mfma_f32_32x32x16_bf16 v[128:143], a[128:131], a[132:135], v[128:143]
    v_add_u32 v23, 0xfffec000, v23
    ds_read_b128 a[156:159], v23 offset:0
    v_add_u32 v31, 0xfffec000, v31
    ds_read_b128 a[160:163], v31 offset:0
    buffer_load_dwordx4 v7, s[48:51], s12 offen offset:1024 lds
    v_mfma_f32_32x32x16_bf16 v[144:159], a[128:131], a[136:139], v[144:159]
    ds_read_b128 a[164:167], v31 offset:4096
    buffer_load_dwordx4 v8, s[48:51], s12 offen offset:2048 lds
    s_waitcnt lgkmcnt(0)
    v_mfma_f32_32x32x16_bf16 v[128:143], a[156:159], a[160:163], v[128:143]
    v_add_u32 v24, 0xfffec000, v24
    ds_read_b128 a[128:131], v24 offset:0
    v_add_u32 v32, 0xfffec000, v32
    ds_read_b128 a[132:135], v32 offset:0
    buffer_load_dwordx4 v9, s[48:51], s12 offen offset:3072 lds
    v_mfma_f32_32x32x16_bf16 v[144:159], a[156:159], a[164:167], v[144:159]
    ds_read_b128 a[136:139], v32 offset:4096
    s_lshr_b32 s3, s93, 1
    s_add_u32 m0, s3, 114688
    s_nop 0
    buffer_load_dwordx4 v10, s[56:59], s13 offen offset:0 lds
    s_waitcnt lgkmcnt(0)
    v_mfma_f32_32x32x16_bf16 v[128:143], a[128:131], a[132:135], v[128:143]
    v_add_u32 v25, 0xfffec000, v25
    ds_read_b128 a[156:159], v25 offset:0
    v_add_u32 v33, 0xfffec000, v33
    ds_read_b128 a[160:163], v33 offset:0
    buffer_load_dwordx4 v11, s[56:59], s13 offen offset:1024 lds
    v_mfma_f32_32x32x16_bf16 v[144:159], a[128:131], a[136:139], v[144:159]
    ds_read_b128 a[164:167], v33 offset:4096
    s_add_u32 s87, s87, 16384
    buffer_load_dword a255, v243, s[64:67], s87 offen
    s_waitcnt vmcnt(10)
    s_barrier
    s_waitcnt lgkmcnt(0)
    v_mfma_f32_32x32x16_bf16 v[128:143], a[156:159], a[160:163], v[128:143]
    ds_read_b128 a[128:131], v22 offset:40960
    ds_read_b128 a[132:135], v30 offset:40960
    s_xor_b32 s3, s7, 7
    s_mul_i32 s89, s3, 229376
    s_lshl_b32 s3, s3, 7
    s_add_u32 s13, s3, s85
    s_add_u32 s12, s3, s84
    s_add_u32 s89, s89, s86
    s_add_u32 m0, s93, 122880
    s_nop 0
    buffer_load_dwordx4 v6, s[48:51], s12 offen offset:0 lds
    v_mfma_f32_32x32x16_bf16 v[144:159], a[156:159], a[164:167], v[144:159]
    ds_read_b128 a[136:139], v30 offset:45056
    buffer_load_dwordx4 v7, s[48:51], s12 offen offset:1024 lds
    s_waitcnt lgkmcnt(0)
    v_mfma_f32_32x32x16_bf16 v[128:143], a[128:131], a[132:135], v[128:143]
    ds_read_b128 a[156:159], v23 offset:40960
    ds_read_b128 a[160:163], v31 offset:40960
    buffer_load_dwordx4 v8, s[48:51], s12 offen offset:2048 lds
    v_mfma_f32_32x32x16_bf16 v[144:159], a[128:131], a[136:139], v[144:159]
    ds_read_b128 a[164:167], v31 offset:45056
    buffer_load_dwordx4 v9, s[48:51], s12 offen offset:3072 lds
    s_waitcnt lgkmcnt(0)
    v_mfma_f32_32x32x16_bf16 v[128:143], a[156:159], a[160:163], v[128:143]
    ds_read_b128 a[128:131], v24 offset:40960
    ds_read_b128 a[132:135], v32 offset:40960
    s_lshr_b32 s3, s93, 1
    s_add_u32 m0, s3, 155648
    s_nop 0
    buffer_load_dwordx4 v10, s[56:59], s13 offen offset:0 lds
    v_mfma_f32_32x32x16_bf16 v[144:159], a[156:159], a[164:167], v[144:159]
    ds_read_b128 a[136:139], v32 offset:45056
    buffer_load_dwordx4 v11, s[56:59], s13 offen offset:1024 lds
    s_waitcnt lgkmcnt(0)
    v_mfma_f32_32x32x16_bf16 v[128:143], a[128:131], a[132:135], v[128:143]
    ds_read_b128 a[156:159], v25 offset:40960
    ds_read_b128 a[160:163], v33 offset:40960
    s_add_u32 s87, s87, 16384
    buffer_load_dword a255, v243, s[64:67], s87 offen
    v_mfma_f32_32x32x16_bf16 v[144:159], a[128:131], a[136:139], v[144:159]
    ds_read_b128 a[164:167], v33 offset:45056
    s_waitcnt vmcnt(8)
    s_barrier
    s_waitcnt lgkmcnt(0)
    v_mfma_f32_32x32x16_bf16 v[128:143], a[156:159], a[160:163], v[128:143]
    v_add_u32 v22, 0x14000, v22
    ds_read_b128 a[128:131], v22 offset:0
    v_add_u32 v30, 0x14000, v30
    ds_read_b128 a[132:135], v30 offset:0
    s_add_u32 s12, s18, 0
    s_add_u32 m0, s94, 0
    s_nop 0
    buffer_load_dwordx4 v18, s[64:67], s12 offen offset:0 lds
    buffer_load_dwordx4 v19, s[64:67], s12 offen offset:1024 lds
    s_lshl_b32 s3, s6, 2
    s_sub_u32 s3, s4, s3
    s_sub_u32 s3, s3, 1
    v_sub_u32 v6, s3, v3
    v_mfma_f32_32x32x16_bf16 v[144:159], a[156:159], a[164:167], v[144:159]
    ds_read_b128 a[136:139], v30 offset:4096
    buffer_load_dwordx4 v20, s[64:67], s12 offen offset:2048 lds
    v_subrev_u32 v7, 2, v6
    v_ashrrev_i32 v8, 31, v6
    v_ashrrev_i32 v9, 31, v7
    v_bfi_b32 v8, v8, 0, s10
    v_bfi_b32 v9, v9, 0, s10
    v_lshlrev_b32 v240, 4, v2
    v_lshl_add_u32 v6, v6, 9, v240
    s_waitcnt lgkmcnt(0)
    v_mfma_f32_32x32x16_bf16 v[128:143], a[128:131], a[132:135], v[128:143]
    v_add_u32 v23, 0x14000, v23
    ds_read_b128 a[156:159], v23 offset:0
    v_add_u32 v31, 0x14000, v31
    ds_read_b128 a[160:163], v31 offset:0
    buffer_load_dwordx4 v21, s[64:67], s12 offen offset:3072 lds
    v_lshl_add_u32 v7, v7, 9, v240
    s_lshr_b32 s3, s93, 3
    s_add_u32 s3, s3, 33792
    v_lshl_add_u32 v16, v1, 3, s3
    v_lshlrev_b32 v17, 3, v2
    v_add_u32 v17, 33792, v17
    s_lshr_b32 s3, s6, 1
    s_mul_i32 s3, s3, 32768
    s_add_u32 s3, s3, s93
    s_add_u32 s89, s3, 73728
    v_mfma_f32_32x32x16_bf16 v[144:159], a[128:131], a[136:139], v[144:159]
    ds_read_b128 a[164:167], v31 offset:4096
    s_add_u32 m0, m0, 4096
    s_xor_b32 s12, s12, 32768
    buffer_load_dwordx4 v18, s[64:67], s12 offen offset:0 lds
    v_lshlrev_b32 v14, 5, v3
    v_lshl_add_u32 v14, v2, 6, v14
    v_add_u32 v14, s89, v14
    v_bfe_u32 v15, v1, 2, 2
    v_lshl_add_u32 v15, v3, 3, v15
    v_lshlrev_b32 v15, 6, v15
    v_and_b32 v240, 1, v1
    s_waitcnt lgkmcnt(0)
    v_mfma_f32_32x32x16_bf16 v[128:143], a[156:159], a[160:163], v[128:143]
    v_add_u32 v24, 0x14000, v24
    ds_read_b128 a[128:131], v24 offset:0
    v_add_u32 v32, 0x14000, v32
    ds_read_b128 a[132:135], v32 offset:0
    buffer_load_dwordx4 v19, s[64:67], s12 offen offset:1024 lds
    v_lshl_add_u32 v15, v240, 5, v15
    v_bfe_u32 v240, v1, 1, 1
    v_lshl_add_u32 v15, v240, 3, v15
    v_bfe_u32 v240, v1, 4, 1
    v_lshl_add_u32 v15, v240, 4, v15
    v_add_u32 v15, s89, v15
    v_mfma_f32_32x32x16_bf16 v[144:159], a[156:159], a[164:167], v[144:159]
    ds_read_b128 a[136:139], v32 offset:4096
    buffer_load_dwordx4 v20, s[64:67], s12 offen offset:2048 lds
    s_lshr_b32 s3, s5, 2
    s_lshl_b32 s3, s3, 3
    s_and_b32 s89, s5, 3
    s_add_u32 s3, s3, s89
    s_lshl_b32 s3, s3, 11
    s_add_u32 s89, s91, s3
    s_add_u32 s89, s89, 114688
    s_lshl_b32 s3, s8, 1
    s_lshr_b32 s96, s6, 1
    s_add_u32 s96, s3, s96
    s_xor_b32 s88, s96, 1
    s_mul_i32 s96, s96, 180224
    s_mul_i32 s88, s88, 180224
    s_add_u32 s96, s96, 1048576
    s_add_u32 s88, s88, 1048576
    s_waitcnt lgkmcnt(0)
    v_mfma_f32_32x32x16_bf16 v[128:143], a[128:131], a[132:135], v[128:143]
    v_add_u32 v25, 0x14000, v25
    ds_read_b128 a[156:159], v25 offset:0
    v_add_u32 v33, 0x14000, v33
    ds_read_b128 a[160:163], v33 offset:0
    buffer_load_dwordx4 v21, s[64:67], s12 offen offset:3072 lds
    v_mfma_f32_32x32x16_bf16 v[144:159], a[128:131], a[136:139], v[144:159]
    ds_read_b128 a[164:167], v33 offset:4096
    s_add_u32 s87, s87, 16384
    buffer_load_dword a255, v243, s[64:67], s87 offen
    s_waitcnt vmcnt(10)
    s_barrier
    s_waitcnt lgkmcnt(0)
    v_mfma_f32_32x32x16_bf16 v[128:143], a[156:159], a[160:163], v[128:143]
    ds_read_b128 a[128:131], v22 offset:40960
    ds_read_b128 a[132:135], v30 offset:40960
    s_lshr_b32 s14, s84, 7
    s_add_u32 s14, s14, 65536
    v_lshlrev_b32 v244, 3, v5
    buffer_load_dwordx2 v[228:229], v244, s[76:79], s14 offen sc1
    s_lshl_b32 s14, s5, 8
    s_add_u32 s14, s14, 210944
    v_lshlrev_b32 v244, 12, v3
    v_lshl_add_u32 v244, v2, 3, v244
    buffer_load_dwordx2 v[208:209], v244, s[76:79], s14 offen sc1
    v_mfma_f32_32x32x16_bf16 v[144:159], a[156:159], a[164:167], v[144:159]
    ds_read_b128 a[136:139], v30 offset:45056
    s_add_u32 s12, s18, 65536
    s_add_u32 m0, s94, 40960
    s_nop 0
    buffer_load_dwordx4 v18, s[64:67], s12 offen offset:0 lds
    s_waitcnt lgkmcnt(0)
    v_mfma_f32_32x32x16_bf16 v[128:143], a[128:131], a[132:135], v[128:143]
    ds_read_b128 a[156:159], v23 offset:40960
    ds_read_b128 a[160:163], v31 offset:40960
    buffer_load_dwordx4 v19, s[64:67], s12 offen offset:1024 lds
    v_mfma_f32_32x32x16_bf16 v[144:159], a[128:131], a[136:139], v[144:159]
    ds_read_b128 a[164:167], v31 offset:45056
    buffer_load_dwordx4 v20, s[64:67], s12 offen offset:2048 lds
    s_waitcnt lgkmcnt(0)
    v_mfma_f32_32x32x16_bf16 v[128:143], a[156:159], a[160:163], v[128:143]
    ds_read_b128 a[128:131], v24 offset:40960
    ds_read_b128 a[132:135], v32 offset:40960
    buffer_load_dwordx4 v21, s[64:67], s12 offen offset:3072 lds
    s_add_u32 m0, m0, 4096
    s_xor_b32 s12, s12, 32768
    buffer_load_dwordx4 v18, s[64:67], s12 offen offset:0 lds
    v_mfma_f32_32x32x16_bf16 v[144:159], a[156:159], a[164:167], v[144:159]
    ds_read_b128 a[136:139], v32 offset:45056
    buffer_load_dwordx4 v19, s[64:67], s12 offen offset:1024 lds
    s_waitcnt lgkmcnt(0)
    v_mfma_f32_32x32x16_bf16 v[128:143], a[128:131], a[132:135], v[128:143]
    ds_read_b128 a[156:159], v25 offset:40960
    ds_read_b128 a[160:163], v33 offset:40960
    buffer_load_dwordx4 v20, s[64:67], s12 offen offset:2048 lds
    v_mfma_f32_32x32x16_bf16 v[144:159], a[128:131], a[136:139], v[144:159]
    ds_read_b128 a[164:167], v33 offset:45056
    buffer_load_dwordx4 v21, s[64:67], s12 offen offset:3072 lds
    s_waitcnt lgkmcnt(0)
    v_mfma_f32_32x32x16_bf16 v[128:143], a[156:159], a[160:163], v[128:143]
    v_mfma_f32_32x32x16_bf16 v[144:159], a[156:159], a[164:167], v[144:159]
    s_waitcnt vmcnt(8)
    v_xor_b32 v244, s10, v229
    v_xor_b32 v245, s10, v209
    v_or_b32 v244, v244, v245
    v_cmp_ne_u32 vcc, 0, v244
    s_mov_b32 s90, 0
    s_nop 0
    s_cbranch_vccnz L_gran_again_3
L_gran_ok_4:
    v_and_b32 v244, 0xffff, v228
    v_and_b32 v245, 0xffff0000, v228
    v_lshlrev_b32 v63, 16, v228
    v_rcp_f32 v249, v245
    v_xor_b32 v244, 0x8000, v244
    v_lshrrev_b32 v245, 16, v228
    v_lshl_or_b32 v244, v244, 16, v244
    v_cndmask_b32 v192, v244, 0, s[98:99]
    v_cndmask_b32 v193, v245, 0, s[98:99]
    v_cndmask_b32 v196, 0, v244, s[98:99]
    v_cndmask_b32 v197, 0, v245, s[98:99]
    v_mov_b32 v209, 0
    s_lshr_b32 s3, s93, 5
    s_add_u32 s3, s3, 32768
    v_lshlrev_b32 v244, 9, v3
    v_lshl_add_u32 v244, v5, 2, v244
    v_add_u32 v244, s3, v244
    v_lshlrev_b32 v246, 6, v3
    v_add_u32 v246, s3, v246
    v_mfma_f32_32x32x16_bf16 v[128:143], v[192:195], v[208:211], v[128:143]
    v_mfma_f32_32x32x16_bf16 v[144:159], v[196:199], v[208:211], v[144:159]
    v_cndmask_b32 v245, v249, v63, s[98:99]
    v_mul_f32 v248, 0x3fb8aa3b, v249
    ds_write_b32 v244, v245
    ds_read_b128 v[212:215], v246 offset:0
    ds_read_b128 v[216:219], v246 offset:16
    ds_read_b128 v[220:223], v246 offset:32
    ds_read_b128 v[224:227], v246 offset:48
    s_waitcnt lgkmcnt(0)
    s_nop 2
    v_pk_mul_f32 v[128:129], v[128:129], v[212:213]
    v_pk_mul_f32 v[144:145], v[144:145], v[212:213]
    v_pk_mul_f32 v[130:131], v[130:131], v[214:215]
    v_pk_mul_f32 v[146:147], v[146:147], v[214:215]
    v_pk_mul_f32 v[132:133], v[132:133], v[216:217]
    v_pk_mul_f32 v[148:149], v[148:149], v[216:217]
    v_pk_mul_f32 v[134:135], v[134:135], v[218:219]
    v_pk_mul_f32 v[150:151], v[150:151], v[218:219]
    v_pk_mul_f32 v[136:137], v[136:137], v[220:221]
    v_pk_mul_f32 v[152:153], v[152:153], v[220:221]
    v_pk_mul_f32 v[138:139], v[138:139], v[222:223]
    v_pk_mul_f32 v[154:155], v[154:155], v[222:223]
    v_pk_mul_f32 v[140:141], v[140:141], v[224:225]
    v_pk_mul_f32 v[156:157], v[156:157], v[224:225]
    v_pk_mul_f32 v[142:143], v[142:143], v[226:227]
    v_pk_mul_f32 v[158:159], v[158:159], v[226:227]
    v_fmac_f32 v129, v46, v128
    v_fmac_f32 v145, v46, v144
    v_fmac_f32 v129, v48, v144
    v_fmac_f32 v145, v47, v128
    v_fmac_f32 v130, v46, v129
    v_fmac_f32 v146, v46, v145
    v_fmac_f32 v130, v48, v145
    v_fmac_f32 v146, v47, v129
    v_fmac_f32 v131, v46, v130
    v_fmac_f32 v147, v46, v146
    v_fmac_f32 v131, v48, v146
    v_fmac_f32 v147, v47, v130
    v_fmac_f32 v132, v46, v131
    v_fmac_f32 v148, v46, v147
    v_fmac_f32 v132, v48, v147
    v_fmac_f32 v148, v47, v131
    v_fmac_f32 v133, v46, v132
    v_fmac_f32 v149, v46, v148
    v_fmac_f32 v133, v48, v148
    v_fmac_f32 v149, v47, v132
    v_fmac_f32 v134, v46, v133
    v_fmac_f32 v150, v46, v149
    v_fmac_f32 v134, v48, v149
    v_fmac_f32 v150, v47, v133
    v_fmac_f32 v135, v46, v134
    v_fmac_f32 v151, v46, v150
    v_fmac_f32 v135, v48, v150
    v_fmac_f32 v151, v47, v134
    v_fmac_f32 v136, v46, v135
    v_fmac_f32 v152, v46, v151
    v_fmac_f32 v136, v48, v151
    v_fmac_f32 v152, v47, v135
    v_fmac_f32 v137, v46, v136
    v_fmac_f32 v153, v46, v152
    v_fmac_f32 v137, v48, v152
    v_fmac_f32 v153, v47, v136
    v_fmac_f32 v138, v46, v137
    v_fmac_f32 v154, v46, v153
    v_fmac_f32 v138, v48, v153
    v_fmac_f32 v154, v47, v137
    v_fmac_f32 v139, v46, v138
    v_fmac_f32 v155, v46, v154
    v_fmac_f32 v139, v48, v154
    v_fmac_f32 v155, v47, v138
    v_fmac_f32 v140, v46, v139
    v_fmac_f32 v156, v46, v155
    v_fmac_f32 v140, v48, v155
    v_fmac_f32 v156, v47, v139
    v_fmac_f32 v141, v46, v140
    v_fmac_f32 v157, v46, v156
    v_fmac_f32 v141, v48, v156
    v_fmac_f32 v157, v47, v140
    v_fmac_f32 v142, v46, v141
    v_fmac_f32 v158, v46, v157
    v_fmac_f32 v142, v48, v157
    v_fmac_f32 v158, v47, v141
    v_fmac_f32 v143, v46, v142
    v_fmac_f32 v159, v46, v158
    v_fmac_f32 v143, v48, v158
    v_fmac_f32 v159, v47, v142
    ds_write2_b32 v16, v143, v159 offset0:0 offset1:1
    s_waitcnt lgkmcnt(0)
    s_barrier
    s_add_u32 s12, s18, 131072
    s_add_u32 m0, s94, 81920
    s_nop 0
    buffer_load_dwordx4 v18, s[64:67], s12 offen offset:0 lds
    ds_read_b64 v[228:229], v17 offset:0
    ds_read_b64 v[230:231], v17 offset:256
    ds_read_b64 v[232:233], v17 offset:512
    ds_read_b64 v[234:235], v17 offset:768
    ds_read_b64 v[236:237], v17 offset:1024
    ds_read_b64 v[238:239], v17 offset:1280
    ds_read_b64 v[240:241], v17 offset:1536
    buffer_load_dwordx4 v19, s[64:67], s12 offen offset:1024 lds
    ds_read_b64 v[242:243], v17 offset:1792
    s_lshl_b32 s3, s6, 1
    v_add_u32 v245, s3, v3
    v_mov_b32 v61, 0
    v_mov_b32 v62, 0
    v_mov_b32 v193, s10
    v_mov_b32 v195, s10
    buffer_load_dwordx4 v20, s[64:67], s12 offen offset:2048 lds
    s_waitcnt lgkmcnt(4)
    v_cmp_eq_u32 vcc, 1, v245
    v_fmac_f32 v230, v49, v228
    v_fmac_f32 v231, v49, v229
    v_cndmask_b32 v61, v61, v228, vcc
    v_cndmask_b32 v62, v62, v229, vcc
    v_fma_f32 v230, v51, v229, v230
    buffer_load_dwordx4 v21, s[64:67], s12 offen offset:3072 lds
    v_fma_f32 v231, v50, v228, v231
    v_cmp_eq_u32 vcc, 2, v245
    v_fmac_f32 v232, v49, v230
    v_fmac_f32 v233, v49, v231
    v_cndmask_b32 v61, v61, v230, vcc
    v_cndmask_b32 v62, v62, v231, vcc
    s_add_u32 m0, m0, 4096
    s_xor_b32 s12, s12, 32768
    buffer_load_dwordx4 v18, s[64:67], s12 offen offset:0 lds
    v_fma_f32 v232, v51, v231, v232
    v_fma_f32 v233, v50, v230, v233
    v_cmp_eq_u32 vcc, 3, v245
    v_fmac_f32 v234, v49, v232
    v_fmac_f32 v235, v49, v233
    v_cndmask_b32 v61, v61, v232, vcc
    buffer_load_dwordx4 v19, s[64:67], s12 offen offset:1024 lds
    v_cndmask_b32 v62, v62, v233, vcc
    v_fma_f32 v234, v51, v233, v234
    v_fma_f32 v235, v50, v232, v235
    s_waitcnt lgkmcnt(0)
    v_cmp_eq_u32 vcc, 4, v245
    v_fmac_f32 v236, v49, v234
    v_fmac_f32 v237, v49, v235
    buffer_load_dwordx4 v20, s[64:67], s12 offen offset:2048 lds
    v_cndmask_b32 v61, v61, v234, vcc
    v_cndmask_b32 v62, v62, v235, vcc
    v_fma_f32 v236, v51, v235, v236
    v_fma_f32 v237, v50, v234, v237
    v_cmp_eq_u32 vcc, 5, v245
    v_fmac_f32 v238, v49, v236
    buffer_load_dwordx4 v21, s[64:67], s12 offen offset:3072 lds
    v_fmac_f32 v239, v49, v237
    v_cndmask_b32 v61, v61, v236, vcc
    v_cndmask_b32 v62, v62, v237, vcc
    v_fma_f32 v238, v51, v237, v238
    v_fma_f32 v239, v50, v236, v239
    v_cmp_eq_u32 vcc, 6, v245
    s_add_u32 s12, s18, 196608
    s_add_u32 m0, s94, 122880
    s_nop 0
    buffer_load_dwordx4 v18, s[64:67], s12 offen offset:0 lds
    v_fmac_f32 v240, v49, v238
    v_fmac_f32 v241, v49, v239
    v_cndmask_b32 v61, v61, v238, vcc
    v_cndmask_b32 v62, v62, v239, vcc
    v_fma_f32 v240, v51, v239, v240
    v_fma_f32 v241, v50, v238, v241
    v_cmp_eq_u32 vcc, 7, v245
    buffer_load_dwordx4 v19, s[64:67], s12 offen offset:1024 lds
    v_fmac_f32 v242, v49, v240
    v_fmac_f32 v243, v49, v241
    v_cndmask_b32 v61, v61, v240, vcc
    v_cndmask_b32 v62, v62, v241, vcc
    v_fma_f32 v192, v51, v241, v242
    v_fma_f32 v194, v50, v240, v243
    buffer_load_dwordx4 v20, s[64:67], s12 offen offset:2048 lds
    s_cmp_eq_u32 s6, 3
    s_cselect_b32 s3, 0, 0x10000
    v_lshlrev_b32 v245, 13, v3
    v_add3_u32 v245, v245, v4, s3
    s_lshl_b32 s3, s4, 9
    buffer_store_dwordx4 v[192:195], v245, s[60:63], s3 offen sc1
    ds_read_b64_tr_b16 a[128:129], v42 offset:0
    ds_read_b64_tr_b16 a[130:131], v42 offset:1024
    buffer_load_dwordx4 v21, s[64:67], s12 offen offset:3072 lds
    ds_read_b64_tr_b16 a[132:133], v43 offset:0
    ds_read_b64_tr_b16 a[134:135], v43 offset:1024
    ds_read_b64_tr_b16 a[136:137], v42 offset:2048
    ds_read_b64_tr_b16 a[138:139], v42 offset:3072
    ds_read_b64_tr_b16 a[140:141], v43 offset:2048
    ds_read_b64_tr_b16 a[142:143], v43 offset:3072
    s_add_u32 m0, m0, 4096
    s_xor_b32 s12, s12, 32768
    buffer_load_dwordx4 v18, s[64:67], s12 offen offset:0 lds
    ds_read_b64_tr_b16 a[144:145], v42 offset:4096
    ds_read_b64_tr_b16 a[146:147], v42 offset:5120
    ds_read_b64_tr_b16 a[148:149], v43 offset:4096
    ds_read_b64_tr_b16 a[150:151], v43 offset:5120
    ds_read_b64_tr_b16 a[152:153], v42 offset:6144
    ds_read_b64_tr_b16 a[154:155], v42 offset:7168
    buffer_load_dwordx4 v19, s[64:67], s12 offen offset:1024 lds
    ds_read_b64_tr_b16 a[156:157], v43 offset:6144
    ds_read_b64_tr_b16 a[158:159], v43 offset:7168
    s_waitcnt vmcnt(15)
    ds_read_b64_tr_b16 a[160:161], v42 offset:40960
    ds_read_b64_tr_b16 a[162:163], v42 offset:41984
    ds_read_b64_tr_b16 a[164:165], v43 offset:40960
    ds_read_b64_tr_b16 a[166:167], v43 offset:41984
    buffer_load_dwordx4 v20, s[64:67], s12 offen offset:2048 lds
    ds_read_b64_tr_b16 a[168:169], v42 offset:43008
    ds_read_b64_tr_b16 a[170:171], v42 offset:44032
    ds_read_b64_tr_b16 a[172:173], v43 offset:43008
    ds_read_b64_tr_b16 a[174:175], v43 offset:44032
    ds_read_b64_tr_b16 a[176:177], v42 offset:45056
    ds_read_b64_tr_b16 a[178:179], v42 offset:46080
    buffer_load_dwordx4 v21, s[64:67], s12 offen offset:3072 lds
    ds_read_b64_tr_b16 a[180:181], v43 offset:45056
    ds_read_b64_tr_b16 a[182:183], v43 offset:46080
    ds_read_b64_tr_b16 a[184:185], v42 offset:47104
    ds_read_b64_tr_b16 a[186:187], v42 offset:48128
    ds_read_b64_tr_b16 a[188:189], v43 offset:47104
    ds_read_b64_tr_b16 a[190:191], v43 offset:48128
    s_waitcnt lgkmcnt(0)
    s_add_u32 s12, s18, 262144
    s_add_u32 m0, s94, 0
    s_nop 0
    buffer_load_dwordx4 v18, s[64:67], s12 offen offset:0 lds
    s_waitcnt vmcnt(10)
    ds_read_b64_tr_b16 a[192:193], v44 offset:0
    ds_read_b64_tr_b16 a[194:195], v44 offset:1024
    buffer_load_dwordx4 v19, s[64:67], s12 offen offset:1024 lds
    ds_read_b64_tr_b16 a[196:197], v45 offset:0
    ds_read_b64_tr_b16 a[198:199], v45 offset:1024
    buffer_load_dwordx4 v20, s[64:67], s12 offen offset:2048 lds
    ds_read_b64_tr_b16 a[200:201], v44 offset:2048
    ds_read_b64_tr_b16 a[202:203], v44 offset:3072
    buffer_load_dwordx4 v21, s[64:67], s12 offen offset:3072 lds
    ds_read_b64_tr_b16 a[204:205], v45 offset:2048
    ds_read_b64_tr_b16 a[206:207], v45 offset:3072
    s_add_u32 m0, m0, 4096
    s_xor_b32 s12, s12, 32768
    buffer_load_dwordx4 v18, s[64:67], s12 offen offset:0 lds
    ds_read_b64_tr_b16 a[208:209], v44 offset:4096
    ds_read_b64_tr_b16 a[210:211], v44 offset:5120
    ds_read_b64_tr_b16 a[212:213], v45 offset:4096
    buffer_load_dwordx4 v19, s[64:67], s12 offen offset:1024 lds
    ds_read_b64_tr_b16 a[214:215], v45 offset:5120
    ds_read_b64_tr_b16 a[216:217], v44 offset:6144
    buffer_load_dwordx4 v20, s[64:67], s12 offen offset:2048 lds
    ds_read_b64_tr_b16 a[218:219], v44 offset:7168
    ds_read_b64_tr_b16 a[220:221], v45 offset:6144
    buffer_load_dwordx4 v21, s[64:67], s12 offen offset:3072 lds
    ds_read_b64_tr_b16 a[222:223], v45 offset:7168
    s_waitcnt lgkmcnt(0)
    s_add_u32 s12, s18, 327680
    s_add_u32 m0, s94, 40960
    s_nop 0
    buffer_load_dwordx4 v18, s[64:67], s12 offen offset:0 lds
    v_pk_mul_f32 v[196:197], v[128:129], v[60:61] op_sel_hi:[1,0]
    v_pk_mul_f32 v[128:129], v[128:129], v[58:59] op_sel_hi:[1,0]
    v_pk_fma_f32 v[128:129], v[144:145], v[60:61], v[128:129] op_sel_hi:[1,0,1]
    v_pk_fma_f32 v[144:145], v[144:145], v[58:59], v[196:197] op_sel:[0,1,0] op_sel_hi:[1,1,1]
    buffer_load_dwordx4 v19, s[64:67], s12 offen offset:1024 lds
    v_pk_mul_f32 v[198:199], v[130:131], v[60:61] op_sel_hi:[1,0]
    v_pk_mul_f32 v[130:131], v[130:131], v[58:59] op_sel_hi:[1,0]
    v_pk_fma_f32 v[130:131], v[146:147], v[60:61], v[130:131] op_sel_hi:[1,0,1]
    buffer_load_dwordx4 v20, s[64:67], s12 offen offset:2048 lds
    v_pk_fma_f32 v[146:147], v[146:147], v[58:59], v[198:199] op_sel:[0,1,0] op_sel_hi:[1,1,1]
    v_pk_mul_f32 v[196:197], v[132:133], v[60:61] op_sel_hi:[1,0]
    v_pk_mul_f32 v[132:133], v[132:133], v[58:59] op_sel_hi:[1,0]
    buffer_load_dwordx4 v21, s[64:67], s12 offen offset:3072 lds
    v_pk_fma_f32 v[132:133], v[148:149], v[60:61], v[132:133] op_sel_hi:[1,0,1]
    v_pk_fma_f32 v[148:149], v[148:149], v[58:59], v[196:197] op_sel:[0,1,0] op_sel_hi:[1,1,1]
    v_pk_mul_f32 v[198:199], v[134:135], v[60:61] op_sel_hi:[1,0]
    s_add_u32 m0, m0, 4096
    s_xor_b32 s12, s12, 32768
    buffer_load_dwordx4 v18, s[64:67], s12 offen offset:0 lds
    v_pk_mul_f32 v[134:135], v[134:135], v[58:59] op_sel_hi:[1,0]
    v_pk_fma_f32 v[134:135], v[150:151], v[60:61], v[134:135] op_sel_hi:[1,0,1]
    v_pk_fma_f32 v[150:151], v[150:151], v[58:59], v[198:199] op_sel:[0,1,0] op_sel_hi:[1,1,1]
    buffer_load_dwordx4 v19, s[64:67], s12 offen offset:1024 lds
    v_pk_mul_f32 v[196:197], v[136:137], v[60:61] op_sel_hi:[1,0]
    v_pk_mul_f32 v[136:137], v[136:137], v[58:59] op_sel_hi:[1,0]
    v_pk_fma_f32 v[136:137], v[152:153], v[60:61], v[136:137] op_sel_hi:[1,0,1]
    buffer_load_dwordx4 v20, s[64:67], s12 offen offset:2048 lds
    v_pk_fma_f32 v[152:153], v[152:153], v[58:59], v[196:197] op_sel:[0,1,0] op_sel_hi:[1,1,1]
    v_pk_mul_f32 v[198:199], v[138:139], v[60:61] op_sel_hi:[1,0]
    v_pk_mul_f32 v[138:139], v[138:139], v[58:59] op_sel_hi:[1,0]
    buffer_load_dwordx4 v21, s[64:67], s12 offen offset:3072 lds
    v_pk_fma_f32 v[138:139], v[154:155], v[60:61], v[138:139] op_sel_hi:[1,0,1]
    v_pk_fma_f32 v[154:155], v[154:155], v[58:59], v[198:199] op_sel:[0,1,0] op_sel_hi:[1,1,1]
    v_pk_mul_f32 v[196:197], v[140:141], v[60:61] op_sel_hi:[1,0]
    s_add_u32 s12, s18, 393216
    s_add_u32 m0, s94, 81920
    s_nop 0
    buffer_load_dwordx4 v18, s[64:67], s12 offen offset:0 lds
    v_pk_mul_f32 v[140:141], v[140:141], v[58:59] op_sel_hi:[1,0]
    v_pk_fma_f32 v[140:141], v[156:157], v[60:61], v[140:141] op_sel_hi:[1,0,1]
    v_pk_fma_f32 v[156:157], v[156:157], v[58:59], v[196:197] op_sel:[0,1,0] op_sel_hi:[1,1,1]
    buffer_load_dwordx4 v19, s[64:67], s12 offen offset:1024 lds
    v_pk_mul_f32 v[198:199], v[142:143], v[60:61] op_sel_hi:[1,0]
    v_pk_mul_f32 v[142:143], v[142:143], v[58:59] op_sel_hi:[1,0]
    v_pk_fma_f32 v[142:143], v[158:159], v[60:61], v[142:143] op_sel_hi:[1,0,1]
    buffer_load_dwordx4 v20, s[64:67], s12 offen offset:2048 lds
    v_pk_fma_f32 v[158:159], v[158:159], v[58:59], v[198:199] op_sel:[0,1,0] op_sel_hi:[1,1,1]
    s_waitcnt vmcnt(19)
    ds_read_b64_tr_b16 a[224:225], v44 offset:40960
    buffer_load_dwordx4 v21, s[64:67], s12 offen offset:3072 lds
    ds_read_b64_tr_b16 a[226:227], v44 offset:41984
    ds_read_b64_tr_b16 a[228:229], v45 offset:40960
    ds_read_b64_tr_b16 a[230:231], v45 offset:41984
    s_add_u32 m0, m0, 4096
    s_xor_b32 s12, s12, 32768
    buffer_load_dwordx4 v18, s[64:67], s12 offen offset:0 lds
    ds_read_b64_tr_b16 a[232:233], v44 offset:43008
    ds_read_b64_tr_b16 a[234:235], v44 offset:44032
    ds_read_b64_tr_b16 a[236:237], v45 offset:43008
    buffer_load_dwordx4 v19, s[64:67], s12 offen offset:1024 lds
    ds_read_b64_tr_b16 a[238:239], v45 offset:44032
    ds_read_b64_tr_b16 a[240:241], v44 offset:45056
    ds_read_b64_tr_b16 a[242:243], v44 offset:46080
    buffer_load_dwordx4 v20, s[64:67], s12 offen offset:2048 lds
    ds_read_b64_tr_b16 a[244:245], v45 offset:45056
    ds_read_b64_tr_b16 a[246:247], v45 offset:46080
    ds_read_b64_tr_b16 a[248:249], v44 offset:47104
    buffer_load_dwordx4 v21, s[64:67], s12 offen offset:3072 lds
    ds_read_b64_tr_b16 a[250:251], v44 offset:48128
    ds_read_b64_tr_b16 a[252:253], v45 offset:47104
    ds_read_b64_tr_b16 a[254:255], v45 offset:48128
    s_waitcnt vmcnt(16)
    ds_read_b64_tr_b16 a[96:97], v42 offset:0
    ds_read_b64_tr_b16 a[98:99], v42 offset:1024
    ds_read_b64_tr_b16 a[100:101], v43 offset:0
    ds_read_b64_tr_b16 a[102:103], v43 offset:1024
    ds_read_b64_tr_b16 a[104:105], v42 offset:2048
    ds_read_b64_tr_b16 a[106:107], v42 offset:3072
    ds_read_b64_tr_b16 a[108:109], v43 offset:2048
    ds_read_b64_tr_b16 a[110:111], v43 offset:3072
    ds_read_b64_tr_b16 a[112:113], v42 offset:4096
    ds_read_b64_tr_b16 a[114:115], v42 offset:5120
    ds_read_b64_tr_b16 a[116:117], v43 offset:4096
    ds_read_b64_tr_b16 a[118:119], v43 offset:5120
    ds_read_b64_tr_b16 a[120:121], v42 offset:6144
    ds_read_b64_tr_b16 a[122:123], v42 offset:7168
    ds_read_b64_tr_b16 a[124:125], v43 offset:6144
    ds_read_b64_tr_b16 a[126:127], v43 offset:7168
    s_waitcnt lgkmcnt(0)
    s_lshl_b32 s12, s9, 1
    s_and_b32 s3, s6, 1
    s_or_b32 s12, s12, s3
    s_lshl_b32 s12, s12, 15
    s_lshl_b32 s3, s6, 8
    s_add_u32 s12, s12, s3
    s_add_u32 m0, s94, 122880
    s_nop 0
    buffer_load_dwordx4 v10, s[68:71], s12 offen offset:0 lds
    buffer_load_dwordx4 v11, s[68:71], s12 offen offset:1024 lds
    buffer_load_dwordx4 v12, s[68:71], s12 offen offset:2048 lds
    buffer_load_dwordx4 v13, s[68:71], s12 offen offset:3072 lds
    s_add_u32 m0, m0, 4096
    s_xor_b32 s12, s12, 32768
    buffer_load_dwordx4 v10, s[68:71], s12 offen offset:0 lds
    buffer_load_dwordx4 v11, s[68:71], s12 offen offset:1024 lds
    buffer_load_dwordx4 v12, s[68:71], s12 offen offset:2048 lds
    buffer_load_dwordx4 v13, s[68:71], s12 offen offset:3072 lds
    s_waitcnt lgkmcnt(0)
L_join:
    s_mov_b32 s3, s24
    v_bfe_u32 v251, v1, 1, 2
    v_add_u32 v251, s3, v251
    v_min_u32 v251, 13, v251
    v_and_b32 v252, 1, v1
    v_lshl_add_u32 v251, v251, 2, v252
    v_lshlrev_b32 v251, 7, v251
    s_lshl_b32 s3, s4, 5
    s_lshr_b32 s15, s5, 3
    s_add_u32 s3, s3, s15
    s_lshl_b32 s3, s3, 8
    s_add_u32 s15, s3, 655360
    buffer_load_dword v252, v251, s[76:79], s15 offen sc1
    buffer_load_dwordx4 v[228:231], v6, s[60:63], 0 offen sc1
    buffer_load_dwordx4 v[232:235], v7, s[60:63], 0 offen sc1
    s_lshl_b32 s12, s9, 1
    s_and_b32 s3, s6, 1
    s_or_b32 s12, s12, s3
    s_lshl_b32 s12, s12, 15
    s_lshl_b32 s3, s6, 8
    s_add_u32 s12, s12, s3
    s_add_u32 s12, s12, 128
    s_add_u32 m0, s94, 0
    s_nop 0
    buffer_load_dwordx4 v10, s[68:71], s12 offen offset:0 lds
    buffer_load_dwordx4 v11, s[68:71], s12 offen offset:1024 lds
    buffer_load_dwordx4 v12, s[68:71], s12 offen offset:2048 lds
    buffer_load_dwordx4 v13, s[68:71], s12 offen offset:3072 lds
    s_add_u32 m0, m0, 4096
    s_xor_b32 s12, s12, 32768
    buffer_load_dwordx4 v10, s[68:71], s12 offen offset:0 lds
    buffer_load_dwordx4 v11, s[68:71], s12 offen offset:1024 lds
    buffer_load_dwordx4 v12, s[68:71], s12 offen offset:2048 lds
    buffer_load_dwordx4 v13, s[68:71], s12 offen offset:3072 lds
    s_waitcnt vmcnt(10)
    v_cmp_ne_u32 vcc, s10, v252
    s_mov_b32 s90, 0
    s_nop 0
    s_cbranch_vccnz L_poll1_again_5
L_poll1_ok_6:
    s_add_u32 s3, s21, 0
    s_add_u32 s13, s96, s3
    s_add_u32 s14, s88, s3
    buffer_load_dwordx4 a[0:3], v4, s[76:79], s13 offen offset:0 sc1
    buffer_load_dwordx4 a[4:7], v4, s[76:79], s14 offen offset:0 sc1
    buffer_load_dwordx4 a[8:11], v4, s[76:79], s13 offen offset:1024 sc1
    buffer_load_dwordx4 a[12:15], v4, s[76:79], s14 offen offset:1024 sc1
    buffer_load_dwordx4 a[16:19], v4, s[76:79], s13 offen offset:2048 sc1
    buffer_load_dwordx4 a[20:23], v4, s[76:79], s14 offen offset:2048 sc1
    buffer_load_dwordx4 a[24:27], v4, s[76:79], s13 offen offset:3072 sc1
    buffer_load_dwordx4 a[28:31], v4, s[76:79], s14 offen offset:3072 sc1
    s_waitcnt vmcnt(16)
    v_xor_b32 v240, v229, v8
    v_xor_b32 v241, v231, v8
    v_or_b32 v240, v240, v241
    v_xor_b32 v241, v233, v9
    v_or_b32 v240, v240, v241
    v_xor_b32 v241, v235, v9
    v_or_b32 v240, v240, v241
    v_cmp_ne_u32 vcc, 0, v240
    s_mov_b32 s90, 0
    s_nop 0
    s_cbranch_vccnz L_e_again_7
L_e_ok_8:
    v_fmac_f32 v228, v54, v232
    v_fmac_f32 v230, v54, v234
    v_fma_f32 v228, -v55, v234, v228
    v_fmac_f32 v230, v55, v232
    v_mul_f32 v240, v56, v228
    v_mul_f32 v241, v56, v230
    v_fma_f32 v240, -v57, v230, v240
    v_fmac_f32 v241, v57, v228
    ds_write_b64 v16, v[240:241] offset:3072
    s_waitcnt lgkmcnt(0)
    s_barrier
    ds_read_b64 v[228:229], v17 offset:3072
    ds_read_b64 v[230:231], v17 offset:3328
    ds_read_b64 v[232:233], v17 offset:3584
    ds_read_b64 v[234:235], v17 offset:3840
    ds_read_b64 v[236:237], v17 offset:4096
    ds_read_b64 v[238:239], v17 offset:4352
    ds_read_b64 v[240:241], v17 offset:4608
    ds_read_b64 v[242:243], v17 offset:4864
    s_add_u32 s3, s21, 4096
    s_add_u32 s13, s96, s3
    s_add_u32 s14, s88, s3
    buffer_load_dwordx4 a[32:35], v4, s[76:79], s13 offen offset:0 sc1
    s_waitcnt lgkmcnt(0)
    v_pk_add_f32 v[228:229], v[228:229], v[236:237]
    v_pk_add_f32 v[230:231], v[230:231], v[238:239]
    v_pk_add_f32 v[232:233], v[232:233], v[240:241]
    v_pk_add_f32 v[234:235], v[234:235], v[242:243]
    v_pk_add_f32 v[228:229], v[228:229], v[232:233]
    v_pk_add_f32 v[230:231], v[230:231], v[234:235]
    v_pk_add_f32 v[228:229], v[228:229], v[230:231]
    v_fmac_f32 v61, v52, v228
    v_fmac_f32 v62, v52, v229
    buffer_load_dwordx4 a[36:39], v4, s[76:79], s14 offen offset:0 sc1
    v_fma_f32 v244, -v53, v229, v61
    v_fma_f32 v245, -v53, v228, -v62
    v_pk_fma_f32 v[128:129], v[160:161], v[244:245], v[128:129] op_sel:[0,0,0] op_sel_hi:[1,0,1]
    v_pk_fma_f32 v[128:129], v[176:177], v[244:245], v[128:129] op_sel:[0,1,0] op_sel_hi:[1,1,1]
    v_pk_fma_f32 v[130:131], v[162:163], v[244:245], v[130:131] op_sel:[0,0,0] op_sel_hi:[1,0,1]
    v_pk_fma_f32 v[130:131], v[178:179], v[244:245], v[130:131] op_sel:[0,1,0] op_sel_hi:[1,1,1]
    v_pk_fma_f32 v[132:133], v[164:165], v[244:245], v[132:133] op_sel:[0,0,0] op_sel_hi:[1,0,1]
    v_pk_fma_f32 v[132:133], v[180:181], v[244:245], v[132:133] op_sel:[0,1,0] op_sel_hi:[1,1,1]
    v_pk_fma_f32 v[134:135], v[166:167], v[244:245], v[134:135] op_sel:[0,0,0] op_sel_hi:[1,0,1]
    buffer_load_dwordx4 a[40:43], v4, s[76:79], s13 offen offset:1024 sc1
    v_pk_fma_f32 v[134:135], v[182:183], v[244:245], v[134:135] op_sel:[0,1,0] op_sel_hi:[1,1,1]
    v_cvt_pk_bf16_f32 v228, v128, v129
    v_cvt_pk_bf16_f32 v229, v130, v131
    v_cvt_pk_bf16_f32 v230, v132, v133
    v_cvt_pk_bf16_f32 v231, v134, v135
    ds_write_b128 v14, v[228:231] offset:0
    v_pk_fma_f32 v[136:137], v[168:169], v[244:245], v[136:137] op_sel:[0,0,0] op_sel_hi:[1,0,1]
    v_pk_fma_f32 v[136:137], v[184:185], v[244:245], v[136:137] op_sel:[0,1,0] op_sel_hi:[1,1,1]
    v_pk_fma_f32 v[138:139], v[170:171], v[244:245], v[138:139] op_sel:[0,0,0] op_sel_hi:[1,0,1]
    buffer_load_dwordx4 a[44:47], v4, s[76:79], s14 offen offset:1024 sc1
    v_pk_fma_f32 v[138:139], v[186:187], v[244:245], v[138:139] op_sel:[0,1,0] op_sel_hi:[1,1,1]
    v_pk_fma_f32 v[140:141], v[172:173], v[244:245], v[140:141] op_sel:[0,0,0] op_sel_hi:[1,0,1]
    v_pk_fma_f32 v[140:141], v[188:189], v[244:245], v[140:141] op_sel:[0,1,0] op_sel_hi:[1,1,1]
    v_pk_fma_f32 v[142:143], v[174:175], v[244:245], v[142:143] op_sel:[0,0,0] op_sel_hi:[1,0,1]
    v_pk_fma_f32 v[142:143], v[190:191], v[244:245], v[142:143] op_sel:[0,1,0] op_sel_hi:[1,1,1]
    v_cvt_pk_bf16_f32 v232, v136, v137
    v_cvt_pk_bf16_f32 v233, v138, v139
    v_cvt_pk_bf16_f32 v234, v140, v141
    v_cvt_pk_bf16_f32 v235, v142, v143
    buffer_load_dwordx4 a[48:51], v4, s[76:79], s13 offen offset:2048 sc1
    ds_write_b128 v14, v[232:235] offset:16
    ds_read_b64_tr_b16 v[128:129], v15 offset:0
    ds_read_b64_tr_b16 v[130:131], v15 offset:256
    ds_read_b64_tr_b16 v[132:133], v15 offset:1024
    ds_read_b64_tr_b16 v[134:135], v15 offset:1280
    v_pk_fma_f32 v[144:145], v[160:161], v[244:245], v[144:145] op_sel:[0,1,0] op_sel_hi:[1,1,1]
    v_pk_fma_f32 v[144:145], v[176:177], v[244:245], v[144:145] op_sel:[0,0,0] op_sel_hi:[1,0,1] neg_lo:[0,1,0] neg_hi:[0,1,0]
    v_pk_fma_f32 v[146:147], v[162:163], v[244:245], v[146:147] op_sel:[0,1,0] op_sel_hi:[1,1,1]
    v_pk_fma_f32 v[146:147], v[178:179], v[244:245], v[146:147] op_sel:[0,0,0] op_sel_hi:[1,0,1] neg_lo:[0,1,0] neg_hi:[0,1,0]
    buffer_load_dwordx4 a[52:55], v4, s[76:79], s14 offen offset:2048 sc1
    v_pk_fma_f32 v[148:149], v[164:165], v[244:245], v[148:149] op_sel:[0,1,0] op_sel_hi:[1,1,1]
    v_pk_fma_f32 v[148:149], v[180:181], v[244:245], v[148:149] op_sel:[0,0,0] op_sel_hi:[1,0,1] neg_lo:[0,1,0] neg_hi:[0,1,0]
    v_pk_fma_f32 v[150:151], v[166:167], v[244:245], v[150:151] op_sel:[0,1,0] op_sel_hi:[1,1,1]
    v_pk_fma_f32 v[150:151], v[182:183], v[244:245], v[150:151] op_sel:[0,0,0] op_sel_hi:[1,0,1] neg_lo:[0,1,0] neg_hi:[0,1,0]
    v_cvt_pk_bf16_f32 v236, v144, v145
    v_cvt_pk_bf16_f32 v237, v146, v147
    v_cvt_pk_bf16_f32 v238, v148, v149
    v_cvt_pk_bf16_f32 v239, v150, v151
    ds_write_b128 v14, v[236:239] offset:2048
    buffer_load_dwordx4 a[56:59], v4, s[76:79], s13 offen offset:3072 sc1
    v_pk_fma_f32 v[152:153], v[168:169], v[244:245], v[152:153] op_sel:[0,1,0] op_sel_hi:[1,1,1]
    v_pk_fma_f32 v[152:153], v[184:185], v[244:245], v[152:153] op_sel:[0,0,0] op_sel_hi:[1,0,1] neg_lo:[0,1,0] neg_hi:[0,1,0]
    v_pk_fma_f32 v[154:155], v[170:171], v[244:245], v[154:155] op_sel:[0,1,0] op_sel_hi:[1,1,1]
    v_pk_fma_f32 v[154:155], v[186:187], v[244:245], v[154:155] op_sel:[0,0,0] op_sel_hi:[1,0,1] neg_lo:[0,1,0] neg_hi:[0,1,0]
    v_pk_fma_f32 v[156:157], v[172:173], v[244:245], v[156:157] op_sel:[0,1,0] op_sel_hi:[1,1,1]
    v_pk_fma_f32 v[156:157], v[188:189], v[244:245], v[156:157] op_sel:[0,0,0] op_sel_hi:[1,0,1] neg_lo:[0,1,0] neg_hi:[0,1,0]
    v_pk_fma_f32 v[158:159], v[174:175], v[244:245], v[158:159] op_sel:[0,1,0] op_sel_hi:[1,1,1]
    v_pk_fma_f32 v[158:159], v[190:191], v[244:245], v[158:159] op_sel:[0,0,0] op_sel_hi:[1,0,1] neg_lo:[0,1,0] neg_hi:[0,1,0]
    v_cvt_pk_bf16_f32 v240, v152, v153
    buffer_load_dwordx4 a[60:63], v4, s[76:79], s14 offen offset:3072 sc1
    v_cvt_pk_bf16_f32 v241, v154, v155
    v_cvt_pk_bf16_f32 v242, v156, v157
    v_cvt_pk_bf16_f32 v243, v158, v159
    ds_write_b128 v14, v[240:243] offset:2064
    ds_read_b64_tr_b16 v[144:145], v15 offset:2048
    ds_read_b64_tr_b16 v[146:147], v15 offset:2304
    ds_read_b64_tr_b16 v[148:149], v15 offset:3072
    ds_read_b64_tr_b16 v[150:151], v15 offset:3328
    s_waitcnt lgkmcnt(8)
    buffer_store_dwordx4 v[128:131], v4, s[76:79], s89 offen offset:0 sc1
    s_waitcnt lgkmcnt(6)
    buffer_store_dwordx4 v[132:135], v4, s[76:79], s89 offen offset:1024 sc1
    s_waitcnt lgkmcnt(2)
    s_add_u32 s89, s89, 8192
    buffer_store_dwordx4 v[144:147], v4, s[76:79], s89 offen offset:0 sc1
    s_waitcnt lgkmcnt(0)
    buffer_store_dwordx4 v[148:151], v4, s[76:79], s89 offen offset:1024 sc1
    s_waitcnt vmcnt(18)
    v_mfma_f32_32x32x16_bf16 v[64:79], a[0:3], a[128:131], 0
    s_add_u32 s3, s21, 8192
    s_add_u32 s13, s96, s3
    s_add_u32 s14, s88, s3
    buffer_load_dwordx4 a[64:67], v4, s[76:79], s13 offen offset:0 sc1
    v_mfma_f32_32x32x16_bf16 v[80:95], a[0:3], a[132:135], 0
    v_mfma_f32_32x32x16_bf16 v[96:111], a[4:7], a[128:131], 0
    buffer_load_dwordx4 a[68:71], v4, s[76:79], s14 offen offset:0 sc1
    v_mfma_f32_32x32x16_bf16 v[112:127], a[4:7], a[132:135], 0
    s_waitcnt vmcnt(18)
    v_mfma_f32_32x32x16_bf16 v[64:79], a[8:11], a[136:139], v[64:79]
    buffer_load_dwordx4 a[72:75], v4, s[76:79], s13 offen offset:1024 sc1
    v_mfma_f32_32x32x16_bf16 v[80:95], a[8:11], a[140:143], v[80:95]
    v_mfma_f32_32x32x16_bf16 v[96:111], a[12:15], a[136:139], v[96:111]
    buffer_load_dwordx4 a[76:79], v4, s[76:79], s14 offen offset:1024 sc1
    v_mfma_f32_32x32x16_bf16 v[112:127], a[12:15], a[140:143], v[112:127]
    s_waitcnt vmcnt(18)
    v_mfma_f32_32x32x16_bf16 v[64:79], a[16:19], a[144:147], v[64:79]
    buffer_load_dwordx4 a[80:83], v4, s[76:79], s13 offen offset:2048 sc1
    v_mfma_f32_32x32x16_bf16 v[80:95], a[16:19], a[148:151], v[80:95]
    v_mfma_f32_32x32x16_bf16 v[96:111], a[20:23], a[144:147], v[96:111]
    buffer_load_dwordx4 a[84:87], v4, s[76:79], s14 offen offset:2048 sc1
    v_mfma_f32_32x32x16_bf16 v[112:127], a[20:23], a[148:151], v[112:127]
    s_waitcnt vmcnt(18)
    v_mfma_f32_32x32x16_bf16 v[64:79], a[24:27], a[152:155], v[64:79]
    buffer_load_dwordx4 a[88:91], v4, s[76:79], s13 offen offset:3072 sc1
    v_mfma_f32_32x32x16_bf16 v[80:95], a[24:27], a[156:159], v[80:95]
    v_mfma_f32_32x32x16_bf16 v[96:111], a[28:31], a[152:155], v[96:111]
    buffer_load_dwordx4 a[92:95], v4, s[76:79], s14 offen offset:3072 sc1
    v_mfma_f32_32x32x16_bf16 v[112:127], a[28:31], a[156:159], v[112:127]
    s_waitcnt vmcnt(18)
    v_mfma_f32_32x32x16_bf16 v[64:79], a[32:35], a[160:163], v[64:79]
    s_add_u32 s3, s21, 12288
    s_add_u32 s13, s96, s3
    s_add_u32 s14, s88, s3
    buffer_load_dwordx4 a[0:3], v4, s[76:79], s13 offen offset:0 sc1
    v_mfma_f32_32x32x16_bf16 v[80:95], a[32:35], a[164:167], v[80:95]
    v_mfma_f32_32x32x16_bf16 v[96:111], a[36:39], a[160:163], v[96:111]
    buffer_load_dwordx4 a[4:7], v4, s[76:79], s14 offen offset:0 sc1
    v_mfma_f32_32x32x16_bf16 v[112:127], a[36:39], a[164:167], v[112:127]
    s_waitcnt vmcnt(18)
    v_mfma_f32_32x32x16_bf16 v[64:79], a[40:43], a[168:171], v[64:79]
    buffer_load_dwordx4 a[8:11], v4, s[76:79], s13 offen offset:1024 sc1
    v_mfma_f32_32x32x16_bf16 v[80:95], a[40:43], a[172:175], v[80:95]
    v_mfma_f32_32x32x16_bf16 v[96:111], a[44:47], a[168:171], v[96:111]
    buffer_load_dwordx4 a[12:15], v4, s[76:79], s14 offen offset:1024 sc1
    v_mfma_f32_32x32x16_bf16 v[112:127], a[44:47], a[172:175], v[112:127]
    s_lshl_b32 s92, s4, 4
    s_add_u32 s92, s92, s5
    s_lshl_b32 s92, s92, 2
    s_add_u32 s92, s92, s6
    s_lshl_b32 s92, s92, 7
    s_add_u32 s92, s92, 786432
    v_mov_b32 v63, s10
    s_waitcnt vmcnt(12)
    s_mov_b64 exec, 1
    buffer_store_dword v63, off, s[76:79], s92 sc1
    s_mov_b64 exec, -1
    v_mfma_f32_32x32x16_bf16 v[64:79], a[48:51], a[176:179], v[64:79]
    buffer_load_dwordx4 a[16:19], v4, s[76:79], s13 offen offset:2048 sc1
    v_mfma_f32_32x32x16_bf16 v[80:95], a[48:51], a[180:183], v[80:95]
    v_mfma_f32_32x32x16_bf16 v[96:111], a[52:55], a[176:179], v[96:111]
    buffer_load_dwordx4 a[20:23], v4, s[76:79], s14 offen offset:2048 sc1
    v_mfma_f32_32x32x16_bf16 v[112:127], a[52:55], a[180:183], v[112:127]
    v_mfma_f32_32x32x16_bf16 v[64:79], a[56:59], a[184:187], v[64:79]
    buffer_load_dwordx4 a[24:27], v4, s[76:79], s13 offen offset:3072 sc1
    v_mfma_f32_32x32x16_bf16 v[80:95], a[56:59], a[188:191], v[80:95]
    v_mfma_f32_32x32x16_bf16 v[96:111], a[60:63], a[184:187], v[96:111]
    buffer_load_dwordx4 a[28:31], v4, s[76:79], s14 offen offset:3072 sc1
    v_mfma_f32_32x32x16_bf16 v[112:127], a[60:63], a[188:191], v[112:127]
    s_waitcnt vmcnt(15)
    v_mfma_f32_32x32x16_bf16 v[64:79], a[64:67], a[192:195], v[64:79]
    s_add_u32 s3, s21, 16384
    s_add_u32 s13, s96, s3
    s_add_u32 s14, s88, s3
    buffer_load_dwordx4 a[32:35], v4, s[76:79], s13 offen offset:0 sc1
    v_mfma_f32_32x32x16_bf16 v[80:95], a[64:67], a[196:199], v[80:95]
    v_mfma_f32_32x32x16_bf16 v[96:111], a[68:71], a[192:195], v[96:111]
    buffer_load_dwordx4 a[36:39], v4, s[76:79], s14 offen offset:0 sc1
    v_mfma_f32_32x32x16_bf16 v[112:127], a[68:71], a[196:199], v[112:127]
    s_waitcnt vmcnt(15)
    v_mfma_f32_32x32x16_bf16 v[64:79], a[72:75], a[200:203], v[64:79]
    buffer_load_dwordx4 a[40:43], v4, s[76:79], s13 offen offset:1024 sc1
    v_mfma_f32_32x32x16_bf16 v[80:95], a[72:75], a[204:207], v[80:95]
    v_mfma_f32_32x32x16_bf16 v[96:111], a[76:79], a[200:203], v[96:111]
    buffer_load_dwordx4 a[44:47], v4, s[76:79], s14 offen offset:1024 sc1
    v_mfma_f32_32x32x16_bf16 v[112:127], a[76:79], a[204:207], v[112:127]
    s_waitcnt vmcnt(15)
    v_mfma_f32_32x32x16_bf16 v[64:79], a[80:83], a[208:211], v[64:79]
    buffer_load_dwordx4 a[48:51], v4, s[76:79], s13 offen offset:2048 sc1
    v_mfma_f32_32x32x16_bf16 v[80:95], a[80:83], a[212:215], v[80:95]
    v_mfma_f32_32x32x16_bf16 v[96:111], a[84:87], a[208:211], v[96:111]
    buffer_load_dwordx4 a[52:55], v4, s[76:79], s14 offen offset:2048 sc1
    v_mfma_f32_32x32x16_bf16 v[112:127], a[84:87], a[212:215], v[112:127]
    s_waitcnt vmcnt(15)
    v_mfma_f32_32x32x16_bf16 v[64:79], a[88:91], a[216:219], v[64:79]
    buffer_load_dwordx4 a[56:59], v4, s[76:79], s13 offen offset:3072 sc1
    v_mfma_f32_32x32x16_bf16 v[80:95], a[88:91], a[220:223], v[80:95]
    v_mfma_f32_32x32x16_bf16 v[96:111], a[92:95], a[216:219], v[96:111]
    buffer_load_dwordx4 a[60:63], v4, s[76:79], s14 offen offset:3072 sc1
    v_mfma_f32_32x32x16_bf16 v[112:127], a[92:95], a[220:223], v[112:127]
    s_waitcnt vmcnt(15)
    v_mfma_f32_32x32x16_bf16 v[64:79], a[0:3], a[224:227], v[64:79]
    s_add_u32 s3, s21, 20480
    s_add_u32 s13, s96, s3
    s_add_u32 s14, s88, s3
    buffer_load_dwordx4 a[64:67], v4, s[76:79], s13 offen offset:0 sc1
    v_mfma_f32_32x32x16_bf16 v[80:95], a[0:3], a[228:231], v[80:95]
    v_mfma_f32_32x32x16_bf16 v[96:111], a[4:7], a[224:227], v[96:111]
    buffer_load_dwordx4 a[68:71], v4, s[76:79], s14 offen offset:0 sc1
    v_mfma_f32_32x32x16_bf16 v[112:127], a[4:7], a[228:231], v[112:127]
    s_waitcnt vmcnt(15)
    v_mfma_f32_32x32x16_bf16 v[64:79], a[8:11], a[232:235], v[64:79]
    buffer_load_dwordx4 a[72:75], v4, s[76:79], s13 offen offset:1024 sc1
    v_mfma_f32_32x32x16_bf16 v[80:95], a[8:11], a[236:239], v[80:95]
    v_mfma_f32_32x32x16_bf16 v[96:111], a[12:15], a[232:235], v[96:111]
    buffer_load_dwordx4 a[76:79], v4, s[76:79], s14 offen offset:1024 sc1
    v_mfma_f32_32x32x16_bf16 v[112:127], a[12:15], a[236:239], v[112:127]
    s_waitcnt vmcnt(14)
    v_mfma_f32_32x32x16_bf16 v[64:79], a[16:19], a[240:243], v[64:79]
    buffer_load_dwordx4 a[80:83], v4, s[76:79], s13 offen offset:2048 sc1
    v_mfma_f32_32x32x16_bf16 v[80:95], a[16:19], a[244:247], v[80:95]
    v_mfma_f32_32x32x16_bf16 v[96:111], a[20:23], a[240:243], v[96:111]
    buffer_load_dwordx4 a[84:87], v4, s[76:79], s14 offen offset:2048 sc1
    v_mfma_f32_32x32x16_bf16 v[112:127], a[20:23], a[244:247], v[112:127]
    s_waitcnt vmcnt(14)
    v_mfma_f32_32x32x16_bf16 v[64:79], a[24:27], a[248:251], v[64:79]
    buffer_load_dwordx4 a[88:91], v4, s[76:79], s13 offen offset:3072 sc1
    v_mfma_f32_32x32x16_bf16 v[80:95], a[24:27], a[252:255], v[80:95]
    v_mfma_f32_32x32x16_bf16 v[96:111], a[28:31], a[248:251], v[96:111]
    buffer_load_dwordx4 a[92:95], v4, s[76:79], s14 offen offset:3072 sc1
    v_mfma_f32_32x32x16_bf16 v[112:127], a[28:31], a[252:255], v[112:127]
    s_waitcnt vmcnt(14)
    v_mfma_f32_32x32x16_bf16 v[64:79], a[32:35], a[96:99], v[64:79]
    s_lshl_b32 s3, s6, 2
    v_bfe_u32 v251, v1, 1, 2
    v_add_u32 v251, s3, v251
    v_min_u32 v251, 15, v251
    v_and_b32 v252, 1, v1
    v_lshl_add_u32 v251, v251, 2, v252
    v_lshlrev_b32 v251, 7, v251
    s_lshl_b32 s3, s4, 5
    s_lshr_b32 s15, s5, 3
    s_add_u32 s3, s3, s15
    s_lshl_b32 s3, s3, 8
    s_add_u32 s15, s3, 786432
    buffer_load_dword v252, v251, s[76:79], s15 offen sc1
    v_mfma_f32_32x32x16_bf16 v[80:95], a[32:35], a[100:103], v[80:95]
    s_add_u32 s3, s21, 24576
    s_add_u32 s13, s96, s3
    s_add_u32 s14, s88, s3
    buffer_load_dwordx4 a[0:3], v4, s[76:79], s13 offen offset:0 sc1
    v_mfma_f32_32x32x16_bf16 v[96:111], a[36:39], a[96:99], v[96:111]
    buffer_load_dwordx4 a[4:7], v4, s[76:79], s14 offen offset:0 sc1
    v_mfma_f32_32x32x16_bf16 v[112:127], a[36:39], a[100:103], v[112:127]
    s_waitcnt vmcnt(15)
    v_mfma_f32_32x32x16_bf16 v[64:79], a[40:43], a[104:107], v[64:79]
    buffer_load_dwordx4 a[8:11], v4, s[76:79], s13 offen offset:1024 sc1
    v_mfma_f32_32x32x16_bf16 v[80:95], a[40:43], a[108:111], v[80:95]
    buffer_load_dwordx4 a[12:15], v4, s[76:79], s14 offen offset:1024 sc1
    v_mfma_f32_32x32x16_bf16 v[96:111], a[44:47], a[104:107], v[96:111]
    v_mfma_f32_32x32x16_bf16 v[112:127], a[44:47], a[108:111], v[112:127]
    buffer_load_dwordx4 a[16:19], v4, s[76:79], s13 offen offset:2048 sc1
    s_waitcnt vmcnt(16)
    v_mfma_f32_32x32x16_bf16 v[64:79], a[48:51], a[112:115], v[64:79]
    buffer_load_dwordx4 a[20:23], v4, s[76:79], s14 offen offset:2048 sc1
    v_mfma_f32_32x32x16_bf16 v[80:95], a[48:51], a[116:119], v[80:95]
    v_mfma_f32_32x32x16_bf16 v[96:111], a[52:55], a[112:115], v[96:111]
    buffer_load_dwordx4 a[24:27], v4, s[76:79], s13 offen offset:3072 sc1
    v_mfma_f32_32x32x16_bf16 v[112:127], a[52:55], a[116:119], v[112:127]
    buffer_load_dwordx4 a[28:31], v4, s[76:79], s14 offen offset:3072 sc1
    s_waitcnt vmcnt(17)
    v_mfma_f32_32x32x16_bf16 v[64:79], a[56:59], a[120:123], v[64:79]
    ds_read_b64_tr_b16 a[128:129], v42 offset:40960
    v_mfma_f32_32x32x16_bf16 v[80:95], a[56:59], a[124:127], v[80:95]
    ds_read_b64_tr_b16 a[130:131], v42 offset:41984
    s_lshl_b32 s14, s8, 1
    s_lshr_b32 s3, s6, 1
    s_add_u32 s14, s14, s3
    s_lshl_b32 s14, s14, 15
    s_lshl_b32 s3, s9, 7
    s_add_u32 s14, s14, s3
    s_and_b32 s3, s6, 1
    s_lshl_b32 s3, s3, 6
    s_add_u32 s14, s14, s3
    v_lshrrev_b32 v247, 2, v1
    v_and_b32 v246, 3, v1
    v_lshlrev_b32 v246, 4, v246
    v_lshl_add_u32 v247, v247, 10, v246
    s_lshr_b32 s3, s93, 1
    s_add_u32 m0, s3, 155648
    s_nop 0
    buffer_load_dwordx4 v247, s[48:51], s14 offen lds
    v_mfma_f32_32x32x16_bf16 v[96:111], a[60:63], a[120:123], v[96:111]
    ds_read_b64_tr_b16 a[132:133], v43 offset:40960
    s_add_u32 s14, s14, 15360
    buffer_load_dwordx4 v247, s[48:51], s14 offen offset:1024 lds
    v_mfma_f32_32x32x16_bf16 v[112:127], a[60:63], a[124:127], v[112:127]
    ds_read_b64_tr_b16 a[134:135], v43 offset:41984
    s_waitcnt vmcnt(10)
    v_cmp_ne_u32 vcc, s10, v252
    s_mov_b32 s90, 0
    s_nop 0
    s_cbranch_vccnz L_poll3_again_9
L_poll3_ok_10:
    s_waitcnt lgkmcnt(0)
    v_mfma_f32_32x32x16_bf16 v[64:79], a[64:67], a[128:131], v[64:79]
    ds_read_b64_tr_b16 a[136:137], v42 offset:43008
    s_lshl_b32 s3, s6, 14
    s_add_u32 s3, s3, 114688
    s_add_u32 s13, s96, s3
    s_add_u32 s14, s88, s3
    buffer_load_dwordx4 a[32:35], v4, s[76:79], s13 offen offset:0 sc1
    v_mfma_f32_32x32x16_bf16 v[80:95], a[64:67], a[132:135], v[80:95]
    ds_read_b64_tr_b16 a[138:139], v42 offset:44032
    v_mfma_f32_32x32x16_bf16 v[96:111], a[68:71], a[128:131], v[96:111]
    ds_read_b64_tr_b16 a[140:141], v43 offset:43008
    buffer_load_dwordx4 a[36:39], v4, s[76:79], s14 offen offset:0 sc1
    v_mfma_f32_32x32x16_bf16 v[112:127], a[68:71], a[132:135], v[112:127]
    ds_read_b64_tr_b16 a[142:143], v43 offset:44032
    s_waitcnt lgkmcnt(0)
    v_mfma_f32_32x32x16_bf16 v[64:79], a[72:75], a[136:139], v[64:79]
    ds_read_b64_tr_b16 a[144:145], v42 offset:45056
    buffer_load_dwordx4 a[40:43], v4, s[76:79], s13 offen offset:1024 sc1
    v_mfma_f32_32x32x16_bf16 v[80:95], a[72:75], a[140:143], v[80:95]
    ds_read_b64_tr_b16 a[146:147], v42 offset:46080
    v_mfma_f32_32x32x16_bf16 v[96:111], a[76:79], a[136:139], v[96:111]
    ds_read_b64_tr_b16 a[148:149], v43 offset:45056
    buffer_load_dwordx4 a[44:47], v4, s[76:79], s14 offen offset:1024 sc1
    v_mfma_f32_32x32x16_bf16 v[112:127], a[76:79], a[140:143], v[112:127]
    ds_read_b64_tr_b16 a[150:151], v43 offset:46080
    s_waitcnt lgkmcnt(0)
    v_mfma_f32_32x32x16_bf16 v[64:79], a[80:83], a[144:147], v[64:79]
    ds_read_b64_tr_b16 a[152:153], v42 offset:47104
    buffer_load_dwordx4 a[48:51], v4, s[76:79], s13 offen offset:2048 sc1
    v_mfma_f32_32x32x16_bf16 v[80:95], a[80:83], a[148:151], v[80:95]
    ds_read_b64_tr_b16 a[154:155], v42 offset:48128
    v_mfma_f32_32x32x16_bf16 v[96:111], a[84:87], a[144:147], v[96:111]
    ds_read_b64_tr_b16 a[156:157], v43 offset:47104
    buffer_load_dwordx4 a[52:55], v4, s[76:79], s14 offen offset:2048 sc1
    v_mfma_f32_32x32x16_bf16 v[112:127], a[84:87], a[148:151], v[112:127]
    ds_read_b64_tr_b16 a[158:159], v43 offset:48128
    s_waitcnt lgkmcnt(0)
    v_mfma_f32_32x32x16_bf16 v[64:79], a[88:91], a[152:155], v[64:79]
    ds_read_b64_tr_b16 a[128:129], v44 offset:0
    buffer_load_dwordx4 a[56:59], v4, s[76:79], s13 offen offset:3072 sc1
    v_mfma_f32_32x32x16_bf16 v[80:95], a[88:91], a[156:159], v[80:95]
    ds_read_b64_tr_b16 a[130:131], v44 offset:1024
    v_mfma_f32_32x32x16_bf16 v[96:111], a[92:95], a[152:155], v[96:111]
    ds_read_b64_tr_b16 a[132:133], v45 offset:0
    buffer_load_dwordx4 a[60:63], v4, s[76:79], s14 offen offset:3072 sc1
    v_mfma_f32_32x32x16_bf16 v[112:127], a[92:95], a[156:159], v[112:127]
    ds_read_b64_tr_b16 a[134:135], v45 offset:1024
    s_waitcnt vmcnt(16) lgkmcnt(0)
    v_mfma_f32_32x32x16_bf16 v[64:79], a[0:3], a[128:131], v[64:79]
    ds_read_b64_tr_b16 a[136:137], v44 offset:2048
    s_lshl_b32 s12, s9, 1
    s_and_b32 s3, s6, 1
    s_or_b32 s12, s12, s3
    s_lshl_b32 s12, s12, 15
    s_lshl_b32 s3, s6, 8
    s_add_u32 s12, s12, s3
    s_add_u32 m0, s94, 40960
    s_nop 0
    buffer_load_dwordx4 v10, s[72:75], s12 offen offset:0 lds
    s_lshr_b32 s3, s5, 3
    s_lshl_b32 s3, s3, 1
    s_lshr_b32 s90, s6, 1
    s_add_u32 s3, s3, s90
    s_lshl_b32 s3, s3, 7
    s_add_u32 s3, s3, 32768
    v_lshlrev_b32 v229, 6, v3
    v_add_u32 v229, s3, v229
    v_mfma_f32_32x32x16_bf16 v[80:95], a[0:3], a[132:135], v[80:95]
    ds_read_b64_tr_b16 a[138:139], v44 offset:3072
    buffer_load_dwordx4 v11, s[72:75], s12 offen offset:1024 lds
    ds_read_b128 v[160:163], v229 offset:0
    ds_read_b128 v[176:179], v229 offset:512
    v_mfma_f32_32x32x16_bf16 v[96:111], a[4:7], a[128:131], v[96:111]
    ds_read_b64_tr_b16 a[140:141], v45 offset:2048
    buffer_load_dwordx4 v12, s[72:75], s12 offen offset:2048 lds
    ds_read_b128 v[164:167], v229 offset:16
    ds_read_b128 v[180:183], v229 offset:528
    ds_read_b128 v[168:171], v229 offset:32
    v_mfma_f32_32x32x16_bf16 v[112:127], a[4:7], a[132:135], v[112:127]
    ds_read_b64_tr_b16 a[142:143], v45 offset:3072
    buffer_load_dwordx4 v13, s[72:75], s12 offen offset:3072 lds
    ds_read_b128 v[184:187], v229 offset:544
    ds_read_b128 v[172:175], v229 offset:48
    ds_read_b128 v[188:191], v229 offset:560
    s_waitcnt vmcnt(18) lgkmcnt(3)
    v_mfma_f32_32x32x16_bf16 v[64:79], a[8:11], a[136:139], v[64:79]
    ds_read_b64_tr_b16 a[144:145], v44 offset:4096
    s_add_u32 m0, m0, 4096
    s_xor_b32 s12, s12, 32768
    buffer_load_dwordx4 v10, s[72:75], s12 offen offset:0 lds
    s_lshr_b32 s3, s93, 1
    s_add_u32 s3, s3, 155648
    v_bfe_u32 v230, v1, 2, 2
    v_lshl_add_u32 v230, v3, 4, v230
    v_lshlrev_b32 v230, 6, v230
    v_bfe_u32 v231, v1, 4, 1
    v_lshl_add_u32 v230, v231, 5, v230
    v_and_b32 v231, 3, v1
    v_lshl_add_u32 v230, v231, 3, v230
    v_add_u32 v230, s3, v230
    v_mfma_f32_32x32x16_bf16 v[80:95], a[8:11], a[140:143], v[80:95]
    ds_read_b64_tr_b16 a[146:147], v44 offset:5120
    buffer_load_dwordx4 v11, s[72:75], s12 offen offset:1024 lds
    v_mfma_f32_32x32x16_bf16 v[96:111], a[12:15], a[136:139], v[96:111]
    ds_read_b64_tr_b16 a[148:149], v45 offset:4096
    buffer_load_dwordx4 v12, s[72:75], s12 offen offset:2048 lds
    v_mfma_f32_32x32x16_bf16 v[112:127], a[12:15], a[140:143], v[112:127]
    ds_read_b64_tr_b16 a[150:151], v45 offset:5120
    buffer_load_dwordx4 v13, s[72:75], s12 offen offset:3072 lds
    s_waitcnt vmcnt(16)
    ds_read_b64_tr_b16 v[144:145], v230 offset:0
    ds_read_b64_tr_b16 v[146:147], v230 offset:256
    s_waitcnt lgkmcnt(2)
    v_mfma_f32_32x32x16_bf16 v[64:79], a[16:19], a[144:147], v[64:79]
    ds_read_b64_tr_b16 a[152:153], v44 offset:6144
    s_lshl_b32 s3, s6, 14
    s_add_u32 s3, s3, 118784
    s_add_u32 s13, s96, s3
    s_add_u32 s14, s88, s3
    buffer_load_dwordx4 a[64:67], v4, s[76:79], s13 offen offset:0 sc1
    ds_read_b64_tr_b16 v[148:149], v230 offset:512
    ds_read_b64_tr_b16 v[150:151], v230 offset:768
    s_waitcnt lgkmcnt(0)
    v_lshlrev_b32 v128, 16, v144
    v_mfma_f32_32x32x16_bf16 v[80:95], a[16:19], a[148:151], v[80:95]
    ds_read_b64_tr_b16 a[154:155], v44 offset:7168
    buffer_load_dwordx4 a[68:71], v4, s[76:79], s14 offen offset:0 sc1
    v_sub_f32 v176, v128, v176
    v_mul_f32 v176, v176, v160
    v_mfma_f32_32x32x16_bf16 v[96:111], a[20:23], a[144:147], v[96:111]
    ds_read_b64_tr_b16 a[156:157], v45 offset:6144
    buffer_load_dwordx4 a[72:75], v4, s[76:79], s13 offen offset:1024 sc1
    v_fmac_f32 v128, v176, v250
    v_and_b32 v129, 0xffff0000, v144
    v_sub_f32 v177, v129, v177
    v_mfma_f32_32x32x16_bf16 v[112:127], a[20:23], a[148:151], v[112:127]
    ds_read_b64_tr_b16 a[158:159], v45 offset:7168
    buffer_load_dwordx4 a[76:79], v4, s[76:79], s14 offen offset:1024 sc1
    v_mul_f32 v177, v177, v161
    v_fmac_f32 v129, v177, v250
    v_lshlrev_b32 v130, 16, v145
    s_waitcnt lgkmcnt(0)
    v_mfma_f32_32x32x16_bf16 v[64:79], a[24:27], a[152:155], v[64:79]
    ds_read_b128 a[128:131], v38 offset:40960
    buffer_load_dwordx4 a[80:83], v4, s[76:79], s13 offen offset:2048 sc1
    v_sub_f32 v178, v130, v178
    v_mul_f32 v178, v178, v162
    v_fmac_f32 v130, v178, v250
    v_mfma_f32_32x32x16_bf16 v[80:95], a[24:27], a[156:159], v[80:95]
    buffer_load_dwordx4 a[84:87], v4, s[76:79], s14 offen offset:2048 sc1
    v_and_b32 v131, 0xffff0000, v145
    v_sub_f32 v179, v131, v179
    v_mul_f32 v179, v179, v163
    v_mfma_f32_32x32x16_bf16 v[96:111], a[28:31], a[152:155], v[96:111]
    ds_read_b128 a[132:135], v38 offset:45056
    buffer_load_dwordx4 a[88:91], v4, s[76:79], s13 offen offset:3072 sc1
    v_fmac_f32 v131, v179, v250
    v_lshlrev_b32 v132, 16, v146
    v_mfma_f32_32x32x16_bf16 v[112:127], a[28:31], a[156:159], v[112:127]
    buffer_load_dwordx4 a[92:95], v4, s[76:79], s14 offen offset:3072 sc1
    v_sub_f32 v180, v132, v180
    v_mul_f32 v180, v180, v164
    v_fmac_f32 v132, v180, v250
    s_waitcnt vmcnt(22) lgkmcnt(0)
    v_mfma_f32_32x32x16_bf16 v[64:79], a[32:35], a[128:131], v[64:79]
    ds_read_b128 a[136:139], v39 offset:40960
    s_lshl_b32 s12, s9, 1
    s_and_b32 s3, s6, 1
    s_or_b32 s12, s12, s3
    s_lshl_b32 s12, s12, 15
    s_lshl_b32 s3, s6, 8
    s_add_u32 s12, s12, s3
    s_add_u32 s12, s12, 128
    s_add_u32 m0, s94, 81920
    s_nop 0
    buffer_load_dwordx4 v10, s[72:75], s12 offen offset:0 lds
    v_and_b32 v133, 0xffff0000, v146
    v_sub_f32 v181, v133, v181
    v_mul_f32 v181, v181, v165
    v_mfma_f32_32x32x16_bf16 v[80:95], a[32:35], a[132:135], v[80:95]
    buffer_load_dwordx4 v11, s[72:75], s12 offen offset:1024 lds
    v_fmac_f32 v133, v181, v250
    v_lshlrev_b32 v134, 16, v147
    v_sub_f32 v182, v134, v182
    v_mfma_f32_32x32x16_bf16 v[96:111], a[36:39], a[128:131], v[96:111]
    ds_read_b128 a[140:143], v39 offset:45056
    buffer_load_dwordx4 v12, s[72:75], s12 offen offset:2048 lds
    v_mul_f32 v182, v182, v166
    v_fmac_f32 v134, v182, v250
    v_mfma_f32_32x32x16_bf16 v[112:127], a[36:39], a[132:135], v[112:127]
    buffer_load_dwordx4 v13, s[72:75], s12 offen offset:3072 lds
    v_and_b32 v135, 0xffff0000, v147
    v_sub_f32 v183, v135, v183
    v_mul_f32 v183, v183, v167
    s_waitcnt vmcnt(24) lgkmcnt(0)
    v_mfma_f32_32x32x16_bf16 v[64:79], a[40:43], a[136:139], v[64:79]
    ds_read_b128 a[144:147], v40 offset:40960
    s_add_u32 m0, m0, 4096
    s_xor_b32 s12, s12, 32768
    buffer_load_dwordx4 v10, s[72:75], s12 offen offset:0 lds
    v_fmac_f32 v135, v183, v250
    v_lshlrev_b32 v136, 16, v148
    v_sub_f32 v184, v136, v184
    v_mfma_f32_32x32x16_bf16 v[80:95], a[40:43], a[140:143], v[80:95]
    buffer_load_dwordx4 v11, s[72:75], s12 offen offset:1024 lds
    v_mul_f32 v184, v184, v168
    v_fmac_f32 v136, v184, v250
    v_and_b32 v137, 0xffff0000, v148
    v_mfma_f32_32x32x16_bf16 v[96:111], a[44:47], a[136:139], v[96:111]
    ds_read_b128 a[148:151], v40 offset:45056
    buffer_load_dwordx4 v12, s[72:75], s12 offen offset:2048 lds
    v_sub_f32 v185, v137, v185
    v_mul_f32 v185, v185, v169
    v_fmac_f32 v137, v185, v250
    v_mfma_f32_32x32x16_bf16 v[112:127], a[44:47], a[140:143], v[112:127]
    buffer_load_dwordx4 v13, s[72:75], s12 offen offset:3072 lds
    v_lshlrev_b32 v138, 16, v149
    v_sub_f32 v186, v138, v186
    s_waitcnt vmcnt(26) lgkmcnt(0)
    v_mfma_f32_32x32x16_bf16 v[64:79], a[48:51], a[144:147], v[64:79]
    ds_read_b128 a[152:155], v41 offset:40960
    s_lshl_b32 s3, s6, 14
    s_add_u32 s3, s3, 122880
    s_add_u32 s13, s96, s3
    s_add_u32 s14, s88, s3
    buffer_load_dwordx4 a[0:3], v4, s[76:79], s13 offen offset:0 sc1
    v_mul_f32 v186, v186, v170
    v_fmac_f32 v138, v186, v250
    v_and_b32 v139, 0xffff0000, v149
    v_mfma_f32_32x32x16_bf16 v[80:95], a[48:51], a[148:151], v[80:95]
    buffer_load_dwordx4 a[4:7], v4, s[76:79], s14 offen offset:0 sc1
    v_sub_f32 v187, v139, v187
    v_mul_f32 v187, v187, v171
    v_fmac_f32 v139, v187, v250
    v_mfma_f32_32x32x16_bf16 v[96:111], a[52:55], a[144:147], v[96:111]
    ds_read_b128 a[156:159], v41 offset:45056
    buffer_load_dwordx4 a[8:11], v4, s[76:79], s13 offen offset:1024 sc1
    v_lshlrev_b32 v140, 16, v150
    v_sub_f32 v188, v140, v188
    v_mul_f32 v188, v188, v172
    v_mfma_f32_32x32x16_bf16 v[112:127], a[52:55], a[148:151], v[112:127]
    buffer_load_dwordx4 a[12:15], v4, s[76:79], s14 offen offset:1024 sc1
    v_fmac_f32 v140, v188, v250
    v_and_b32 v141, 0xffff0000, v150
    s_waitcnt vmcnt(28) lgkmcnt(0)
    v_mfma_f32_32x32x16_bf16 v[64:79], a[56:59], a[152:155], v[64:79]
    ds_read_b128 a[128:131], v34 offset:0
    buffer_load_dwordx4 a[16:19], v4, s[76:79], s13 offen offset:2048 sc1
    v_sub_f32 v189, v141, v189
    v_mul_f32 v189, v189, v173
    v_fmac_f32 v141, v189, v250
    v_mfma_f32_32x32x16_bf16 v[80:95], a[56:59], a[156:159], v[80:95]
    buffer_load_dwordx4 a[20:23], v4, s[76:79], s14 offen offset:2048 sc1
    v_lshlrev_b32 v142, 16, v151
    v_sub_f32 v190, v142, v190
    v_mul_f32 v190, v190, v174
    v_mfma_f32_32x32x16_bf16 v[96:111], a[60:63], a[152:155], v[96:111]
    ds_read_b128 a[132:135], v34 offset:4096
    buffer_load_dwordx4 a[24:27], v4, s[76:79], s13 offen offset:3072 sc1
    v_fmac_f32 v142, v190, v250
    v_and_b32 v143, 0xffff0000, v151
    v_sub_f32 v191, v143, v191
    v_mfma_f32_32x32x16_bf16 v[112:127], a[60:63], a[156:159], v[112:127]
    buffer_load_dwordx4 a[28:31], v4, s[76:79], s14 offen offset:3072 sc1
    v_mul_f32 v191, v191, v175
    v_fmac_f32 v143, v191, v250
    s_waitcnt vmcnt(22) lgkmcnt(0)
    v_mfma_f32_32x32x16_bf16 v[64:79], a[64:67], a[128:131], v[64:79]
    ds_read_b128 a[136:139], v35 offset:0
    s_lshl_b32 s3, s6, 14
    s_add_u32 s3, s3, 126976
    s_add_u32 s13, s96, s3
    s_add_u32 s14, s88, s3
    buffer_load_dwordx4 a[32:35], v4, s[76:79], s13 offen offset:0 sc1
    v_mfma_f32_32x32x16_bf16 v[80:95], a[64:67], a[132:135], v[80:95]
    v_mfma_f32_32x32x16_bf16 v[96:111], a[68:71], a[128:131], v[96:111]
    ds_read_b128 a[140:143], v35 offset:4096
    buffer_load_dwordx4 a[36:39], v4, s[76:79], s14 offen offset:0 sc1
    v_mfma_f32_32x32x16_bf16 v[112:127], a[68:71], a[132:135], v[112:127]
    s_waitcnt vmcnt(22) lgkmcnt(0)
    v_mfma_f32_32x32x16_bf16 v[64:79], a[72:75], a[136:139], v[64:79]
    ds_read_b128 a[144:147], v36 offset:0
    buffer_load_dwordx4 a[40:43], v4, s[76:79], s13 offen offset:1024 sc1
    v_mfma_f32_32x32x16_bf16 v[80:95], a[72:75], a[140:143], v[80:95]
    v_mfma_f32_32x32x16_bf16 v[96:111], a[76:79], a[136:139], v[96:111]
    ds_read_b128 a[148:151], v36 offset:4096
    buffer_load_dwordx4 a[44:47], v4, s[76:79], s14 offen offset:1024 sc1
    v_mfma_f32_32x32x16_bf16 v[112:127], a[76:79], a[140:143], v[112:127]
    s_waitcnt vmcnt(22) lgkmcnt(0)
    v_mfma_f32_32x32x16_bf16 v[64:79], a[80:83], a[144:147], v[64:79]
    ds_read_b128 a[152:155], v37 offset:0
    buffer_load_dwordx4 a[48:51], v4, s[76:79], s13 offen offset:2048 sc1
    v_mfma_f32_32x32x16_bf16 v[80:95], a[80:83], a[148:151], v[80:95]
    v_mfma_f32_32x32x16_bf16 v[96:111], a[84:87], a[144:147], v[96:111]
    ds_read_b128 a[156:159], v37 offset:4096
    buffer_load_dwordx4 a[52:55], v4, s[76:79], s14 offen offset:2048 sc1
    v_mfma_f32_32x32x16_bf16 v[112:127], a[84:87], a[148:151], v[112:127]
    s_waitcnt vmcnt(22) lgkmcnt(0)
    v_mfma_f32_32x32x16_bf16 v[64:79], a[88:91], a[152:155], v[64:79]
    ds_read_b128 a[128:131], v34 offset:40960
    buffer_load_dwordx4 a[56:59], v4, s[76:79], s13 offen offset:3072 sc1
    v_mfma_f32_32x32x16_bf16 v[80:95], a[88:91], a[156:159], v[80:95]
    v_mfma_f32_32x32x16_bf16 v[96:111], a[92:95], a[152:155], v[96:111]
    ds_read_b128 a[132:135], v34 offset:45056
    buffer_load_dwordx4 a[60:63], v4, s[76:79], s14 offen offset:3072 sc1
    v_mfma_f32_32x32x16_bf16 v[112:127], a[92:95], a[156:159], v[112:127]
    s_waitcnt vmcnt(14) lgkmcnt(0)
    v_mfma_f32_32x32x16_bf16 v[64:79], a[0:3], a[128:131], v[64:79]
    ds_read_b128 a[136:139], v35 offset:40960
    v_mfma_f32_32x32x16_bf16 v[80:95], a[0:3], a[132:135], v[80:95]
    v_mfma_f32_32x32x16_bf16 v[96:111], a[4:7], a[128:131], v[96:111]
    ds_read_b128 a[140:143], v35 offset:45056
    v_mfma_f32_32x32x16_bf16 v[112:127], a[4:7], a[132:135], v[112:127]
    s_waitcnt vmcnt(12) lgkmcnt(0)
    v_mfma_f32_32x32x16_bf16 v[64:79], a[8:11], a[136:139], v[64:79]
    ds_read_b128 a[144:147], v36 offset:40960
    v_mfma_f32_32x32x16_bf16 v[80:95], a[8:11], a[140:143], v[80:95]
    v_mfma_f32_32x32x16_bf16 v[96:111], a[12:15], a[136:139], v[96:111]
    ds_read_b128 a[148:151], v36 offset:45056
    v_mfma_f32_32x32x16_bf16 v[112:127], a[12:15], a[140:143], v[112:127]
    s_waitcnt vmcnt(10) lgkmcnt(0)
    v_mfma_f32_32x32x16_bf16 v[64:79], a[16:19], a[144:147], v[64:79]
    ds_read_b128 a[152:155], v37 offset:40960
    v_mfma_f32_32x32x16_bf16 v[80:95], a[16:19], a[148:151], v[80:95]
    v_mfma_f32_32x32x16_bf16 v[96:111], a[20:23], a[144:147], v[96:111]
    ds_read_b128 a[156:159], v37 offset:45056
    v_mfma_f32_32x32x16_bf16 v[112:127], a[20:23], a[148:151], v[112:127]
    s_waitcnt vmcnt(8) lgkmcnt(0)
    v_mfma_f32_32x32x16_bf16 v[64:79], a[24:27], a[152:155], v[64:79]
    ds_read_b128 a[128:131], v38 offset:0
    v_mfma_f32_32x32x16_bf16 v[80:95], a[24:27], a[156:159], v[80:95]
    v_mfma_f32_32x32x16_bf16 v[96:111], a[28:31], a[152:155], v[96:111]
    ds_read_b128 a[132:135], v38 offset:4096
    v_mfma_f32_32x32x16_bf16 v[112:127], a[28:31], a[156:159], v[112:127]
    ds_read_b128 a[136:139], v39 offset:0
    ds_read_b128 a[140:143], v39 offset:4096
    ds_read_b128 a[144:147], v40 offset:0
    ds_read_b128 a[148:151], v40 offset:4096
    ds_read_b128 a[152:155], v41 offset:0
    ds_read_b128 a[156:159], v41 offset:4096
    v_add_u32 v228, s94, v4
    v_xor_b32 v229, 8192, v228
    v_xor_b32 v230, 16384, v228
    v_xor_b32 v231, 24576, v228
    s_lshl_b32 s14, s8, 1
    s_lshr_b32 s3, s6, 1
    s_add_u32 s14, s14, s3
    s_lshl_b32 s14, s14, 16
    s_lshl_b32 s3, s9, 8
    s_add_u32 s14, s14, s3
    s_and_b32 s3, s6, 1
    s_lshl_b32 s3, s3, 7
    s_add_u32 s14, s14, s3
    v_lshlrev_b32 v232, 15, v3
    v_lshl_add_u32 v232, v2, 2, v232
    s_waitcnt vmcnt(6) lgkmcnt(6)
    v_mfma_f32_32x32x16_bf16 v[112:127], a[36:39], a[132:135], v[112:127]
    s_waitcnt vmcnt(4) lgkmcnt(4)
    v_mfma_f32_32x32x16_bf16 v[112:127], a[44:47], a[140:143], v[112:127]
    s_waitcnt vmcnt(2) lgkmcnt(2)
    v_mfma_f32_32x32x16_bf16 v[112:127], a[52:55], a[148:151], v[112:127]
    s_waitcnt vmcnt(0) lgkmcnt(0)
    v_mfma_f32_32x32x16_bf16 v[112:127], a[60:63], a[156:159], v[112:127]
    v_mfma_f32_32x32x16_bf16 v[96:111], a[36:39], a[128:131], v[96:111]
    v_mfma_f32_32x32x16_bf16 v[96:111], a[44:47], a[136:139], v[96:111]
    v_mfma_f32_32x32x16_bf16 v[96:111], a[52:55], a[144:147], v[96:111]
    v_mfma_f32_32x32x16_bf16 v[96:111], a[60:63], a[152:155], v[96:111]
    s_nop 7
    ds_write_b128 v228, v[112:115] offset:45056
    v_mfma_f32_32x32x16_bf16 v[80:95], a[32:35], a[132:135], v[80:95]
    ds_write_b128 v228, v[116:119] offset:46080
    v_mfma_f32_32x32x16_bf16 v[80:95], a[40:43], a[140:143], v[80:95]
    ds_write_b128 v228, v[120:123] offset:47104
    v_mfma_f32_32x32x16_bf16 v[80:95], a[48:51], a[148:151], v[80:95]
    ds_write_b128 v228, v[124:127] offset:48128
    v_mfma_f32_32x32x16_bf16 v[80:95], a[56:59], a[156:159], v[80:95]
    ds_write_b128 v228, v[96:99] offset:40960
    v_mfma_f32_32x32x16_bf16 v[64:79], a[32:35], a[128:131], v[64:79]
    ds_write_b128 v228, v[100:103] offset:41984
    v_mfma_f32_32x32x16_bf16 v[64:79], a[40:43], a[136:139], v[64:79]
    ds_write_b128 v228, v[104:107] offset:43008
    v_mfma_f32_32x32x16_bf16 v[64:79], a[48:51], a[144:147], v[64:79]
    ds_write_b128 v228, v[108:111] offset:44032
    v_mfma_f32_32x32x16_bf16 v[64:79], a[56:59], a[152:155], v[64:79]
    s_nop 3
    ds_write_b128 v228, v[80:83] offset:4096
    ds_write_b128 v228, v[84:87] offset:5120
    ds_write_b128 v228, v[88:91] offset:6144
    ds_write_b128 v228, v[92:95] offset:7168
    s_mov_b32 s12, 0x3f317218
    s_waitcnt lgkmcnt(0)
    s_barrier
    ds_read_b128 v[80:83], v229 offset:4096
    ds_read_b128 v[96:99], v230 offset:40960
    ds_read_b128 v[112:115], v231 offset:45056
    ds_read_b128 v[84:87], v229 offset:5120
    ds_read_b128 v[100:103], v230 offset:41984
    ds_read_b128 v[116:119], v231 offset:46080
    ds_read_b128 v[88:91], v229 offset:6144
    ds_read_b128 v[104:107], v230 offset:43008
    ds_read_b128 v[120:123], v231 offset:47104
    ds_read_b128 v[92:95], v229 offset:7168
    ds_read_b128 v[108:111], v230 offset:44032
    ds_read_b128 v[124:127], v231 offset:48128
    s_waitcnt lgkmcnt(9)
    v_pk_add_f32 v[64:65], v[64:65], v[80:81]
    v_pk_add_f32 v[96:97], v[96:97], v[112:113]
    v_pk_add_f32 v[66:67], v[66:67], v[82:83]
    v_pk_add_f32 v[98:99], v[98:99], v[114:115]
    v_pk_add_f32 v[64:65], v[64:65], v[96:97]
    v_pk_fma_f32 v[64:65], v[64:65], s[12:13], v[128:129] op_sel_hi:[1,0,1]
    v_pk_add_f32 v[66:67], v[66:67], v[98:99]
    v_pk_fma_f32 v[66:67], v[66:67], s[12:13], v[130:131] op_sel_hi:[1,0,1]
    buffer_store_dword v64, v232, s[80:83], s14 offen offset:0 sc1
    buffer_store_dword v65, v232, s[80:83], s14 offen offset:2048 sc1
    s_add_u32 s14, s14, 4096
    buffer_store_dword v66, v232, s[80:83], s14 offen offset:0 sc1
    buffer_store_dword v67, v232, s[80:83], s14 offen offset:2048 sc1
    s_add_u32 s14, s14, 4096
    s_waitcnt lgkmcnt(6)
    v_pk_add_f32 v[68:69], v[68:69], v[84:85]
    v_pk_add_f32 v[100:101], v[100:101], v[116:117]
    v_pk_add_f32 v[70:71], v[70:71], v[86:87]
    v_pk_add_f32 v[102:103], v[102:103], v[118:119]
    v_pk_add_f32 v[68:69], v[68:69], v[100:101]
    v_pk_fma_f32 v[68:69], v[68:69], s[12:13], v[132:133] op_sel_hi:[1,0,1]
    v_pk_add_f32 v[70:71], v[70:71], v[102:103]
    v_pk_fma_f32 v[70:71], v[70:71], s[12:13], v[134:135] op_sel_hi:[1,0,1]
    buffer_store_dword v68, v232, s[80:83], s14 offen offset:0 sc1
    buffer_store_dword v69, v232, s[80:83], s14 offen offset:2048 sc1
    s_add_u32 s14, s14, 4096
    buffer_store_dword v70, v232, s[80:83], s14 offen offset:0 sc1
    buffer_store_dword v71, v232, s[80:83], s14 offen offset:2048 sc1
    s_add_u32 s14, s14, 4096
    s_waitcnt lgkmcnt(3)
    v_pk_add_f32 v[72:73], v[72:73], v[88:89]
    v_pk_add_f32 v[104:105], v[104:105], v[120:121]
    v_pk_add_f32 v[74:75], v[74:75], v[90:91]
    v_pk_add_f32 v[106:107], v[106:107], v[122:123]
    v_pk_add_f32 v[72:73], v[72:73], v[104:105]
    v_pk_fma_f32 v[72:73], v[72:73], s[12:13], v[136:137] op_sel_hi:[1,0,1]
    v_pk_add_f32 v[74:75], v[74:75], v[106:107]
    v_pk_fma_f32 v[74:75], v[74:75], s[12:13], v[138:139] op_sel_hi:[1,0,1]
    buffer_store_dword v72, v232, s[80:83], s14 offen offset:0 sc1
    buffer_store_dword v73, v232, s[80:83], s14 offen offset:2048 sc1
    s_add_u32 s14, s14, 4096
    buffer_store_dword v74, v232, s[80:83], s14 offen offset:0 sc1
    buffer_store_dword v75, v232, s[80:83], s14 offen offset:2048 sc1
    s_add_u32 s14, s14, 4096
    s_waitcnt lgkmcnt(0)
    v_pk_add_f32 v[76:77], v[76:77], v[92:93]
    v_pk_add_f32 v[108:109], v[108:109], v[124:125]
    v_pk_add_f32 v[78:79], v[78:79], v[94:95]
    v_pk_add_f32 v[110:111], v[110:111], v[126:127]
    v_pk_add_f32 v[76:77], v[76:77], v[108:109]
    v_pk_fma_f32 v[76:77], v[76:77], s[12:13], v[140:141] op_sel_hi:[1,0,1]
    v_pk_add_f32 v[78:79], v[78:79], v[110:111]
    v_pk_fma_f32 v[78:79], v[78:79], s[12:13], v[142:143] op_sel_hi:[1,0,1]
    buffer_store_dword v76, v232, s[80:83], s14 offen offset:0 sc1
    buffer_store_dword v77, v232, s[80:83], s14 offen offset:2048 sc1
    s_add_u32 s14, s14, 4096
    buffer_store_dword v78, v232, s[80:83], s14 offen offset:0 sc1
    buffer_store_dword v79, v232, s[80:83], s14 offen offset:2048 sc1
    s_add_u32 s14, s14, 4096
    s_cmp_lg_u32 s4, 15
    s_cbranch_scc1 L_fin
    s_or_b32 s3, s5, s6
    s_cmp_lg_u32 s3, 0
    s_cbranch_scc1 L_fin
    v_mov_b32 v233, s10
    s_mov_b64 exec, 1
    buffer_store_dword v233, off, s[76:79], 0 sc1
    s_mov_b64 exec, -1
L_fin:
L_end:
    s_endpgm
L_gran_again_1:
    s_lshr_b32 s14, s84, 7
    s_add_u32 s14, s14, 65536
    v_lshlrev_b32 v244, 3, v5
    buffer_load_dwordx2 v[228:229], v244, s[76:79], s14 offen sc1
    s_lshl_b32 s14, s5, 8
    s_add_u32 s14, s14, 210944
    v_lshlrev_b32 v244, 12, v3
    v_lshl_add_u32 v244, v2, 3, v244
    buffer_load_dwordx2 v[208:209], v244, s[76:79], s14 offen sc1
    s_lshl_b32 s14, s97, 10
    s_add_u32 s14, s14, 196608
    v_lshlrev_b32 v244, 3, v1
    buffer_load_dwordx2 v[200:201], v244, s[76:79], s14 offen sc1
    buffer_load_dwordx2 v[204:205], v244, s[76:79], s14 offen offset:512 sc1
    s_waitcnt vmcnt(0)
    v_xor_b32 v244, s10, v229
    v_xor_b32 v245, s10, v209
    v_or_b32 v244, v244, v245
    v_xor_b32 v245, s10, v201
    v_or_b32 v244, v244, v245
    v_xor_b32 v245, s10, v205
    v_or_b32 v244, v244, v245
    v_cmp_ne_u32 vcc, 0, v244
    s_add_u32 s90, s90, 1
    s_cmp_gt_u32 s90, 65536
    s_cbranch_scc1 L_gran_ok_2
    s_cbranch_vccnz L_gran_again_1
    s_branch L_gran_ok_2
L_gran_again_3:
    s_lshr_b32 s14, s84, 7
    s_add_u32 s14, s14, 65536
    v_lshlrev_b32 v244, 3, v5
    buffer_load_dwordx2 v[228:229], v244, s[76:79], s14 offen sc1
    s_lshl_b32 s14, s5, 8
    s_add_u32 s14, s14, 210944
    v_lshlrev_b32 v244, 12, v3
    v_lshl_add_u32 v244, v2, 3, v244
    buffer_load_dwordx2 v[208:209], v244, s[76:79], s14 offen sc1
    s_waitcnt vmcnt(0)
    v_xor_b32 v244, s10, v229
    v_xor_b32 v245, s10, v209
    v_or_b32 v244, v244, v245
    v_cmp_ne_u32 vcc, 0, v244
    s_add_u32 s90, s90, 1
    s_cmp_gt_u32 s90, 65536
    s_cbranch_scc1 L_gran_ok_4
    s_cbranch_vccnz L_gran_again_3
    s_branch L_gran_ok_4
L_poll1_again_5:
    buffer_load_dword v252, v251, s[76:79], s15 offen sc1
    s_waitcnt vmcnt(0)
    v_cmp_ne_u32 vcc, s10, v252
    s_add_u32 s90, s90, 1
    s_cmp_gt_u32 s90, 65536
    s_cbranch_scc1 L_poll1_ok_6
    s_cbranch_vccnz L_poll1_again_5
    s_branch L_poll1_ok_6
L_e_again_7:
    buffer_load_dwordx4 v[228:231], v6, s[60:63], 0 offen sc1
    buffer_load_dwordx4 v[232:235], v7, s[60:63], 0 offen sc1
    s_waitcnt vmcnt(0)
    v_xor_b32 v240, v229, v8
    v_xor_b32 v241, v231, v8
    v_or_b32 v240, v240, v241
    v_xor_b32 v241, v233, v9
    v_or_b32 v240, v240, v241
    v_xor_b32 v241, v235, v9
    v_or_b32 v240, v240, v241
    v_cmp_ne_u32 vcc, 0, v240
    s_add_u32 s90, s90, 1
    s_cmp_gt_u32 s90, 65536
    s_cbranch_scc1 L_e_ok_8
    s_cbranch_vccnz L_e_again_7
    s_branch L_e_ok_8
L_poll3_again_9:
    buffer_load_dword v252, v251, s[76:79], s15 offen sc1
    s_waitcnt vmcnt(0)
    v_cmp_ne_u32 vcc, s10, v252
    s_add_u32 s90, s90, 1
    s_cmp_gt_u32 s90, 65536
    s_cbranch_scc1 L_poll3_ok_10
    s_cbranch_vccnz L_poll3_again_9
    s_branch L_poll3_ok_10
.section .rodata,"a"
.p2align 6
.amdhsa_kernel parallel_sum__ssm_conv_s5__dense_activation_mish__prompt_kernel
  .amdhsa_next_free_vgpr 512
  .amdhsa_next_free_sgpr 102
  .amdhsa_accum_offset 256
  .amdhsa_group_segment_fixed_size 0
  .amdhsa_kernarg_size 128
  .amdhsa_user_sgpr_count 2
  .amdhsa_user_sgpr_kernarg_segment_ptr 1
  .amdhsa_system_sgpr_workgroup_id_x 1
.end_amdhsa_kernel
```
